```python
import torch

def _softmax(x, axis=-1):
    return torch.softmax(x, dim=axis)
def _gelu(x):
    return torch.nn.functional.gelu(x, approximate="tanh")
def _silu(x):
    return torch.nn.functional.silu(x)
def _sigmoid(x):
    return torch.sigmoid(x)
def _layernorm(x, axis=-1, eps=1e-5):
    m = x.mean(dim=axis, keepdim=True)
    v = x.var(dim=axis, keepdim=True, unbiased=False)
    return (x - m) / torch.sqrt(v + eps)
def _scatter_add(tgt, idx, src, axis=0):
    return tgt.clone().index_add_(axis, idx, src)
def _segment_sum(src, seg, n):
    out = torch.zeros((n,) + src.shape[1:], dtype=src.dtype)
    return out.index_add_(0, seg, src)
def _pad(x, pw):
    flat = tuple(v for pair in reversed(pw) for v in pair)
    return torch.nn.functional.pad(x, flat)

kernel_name = 'sequential_preLN__linear_attn_block__mixer_channel_mlp__prompt'

def setup_inputs():

    _w = (lambda a: (lambda t: t.to(torch.bfloat16) if t.is_floating_point() else t)(torch.as_tensor(a)))
    def _A_setup():
        B, S, D = 1, 2048, 512
        return {
            "x": _w((lambda *s: torch.randn(*s, dtype=torch.bfloat16) * 0.05)(B, S, D)),
            "wqkv": _w((lambda *s: torch.randn(*s, dtype=torch.bfloat16) * 0.1)(D, 3 * D)),
            "wo": _w((lambda *s: torch.randn(*s, dtype=torch.bfloat16) * 0.05)(D, D)),
        }
    _A_in = _A_setup()

    def _B_setup():
        B, S, D, F = 1, 2048, 512, 1376
        return {
            "x": _w((lambda *s: torch.randn(*s, dtype=torch.bfloat16) * 0.05)(B, S, D)),
            "w1": _w((lambda *s: torch.randn(*s, dtype=torch.bfloat16) * 3.2)(D, F) * (D ** -0.5)),
            "b1": _w((lambda *s: torch.randn(*s, dtype=torch.bfloat16) * 0.8)(F)),
            "w2": _w((lambda *s: torch.randn(*s, dtype=torch.bfloat16) * 0.05)(F, D) * (F ** -0.5)),
            "b2": _w((lambda *s: torch.randn(*s, dtype=torch.bfloat16) * 0.05)(D)),
        }
    _B_in = _B_setup()

    return {
        "A_x": _A_in["x"],
        "A_wqkv": _A_in["wqkv"],
        "A_wo": _A_in["wo"],
        "B_x": _B_in["x"],
        "B_w1": _B_in["w1"],
        "B_b1": _B_in["b1"],
        "B_w2": _B_in["w2"],
        "B_b2": _B_in["b2"],
    }

def reference(A_x, A_wqkv, A_wo, B_x, B_w1, B_b1, B_w2, B_b2):
    def _A_ref(x, wqkv, wo):
        B, S, D = x.shape
        H = 32; Dh = D // H
        qkv = (lambda x, *d: x.permute(*d))((x @ wqkv).reshape(B, S, 3, H, Dh), 2, 0, 3, 1, 4)
        q, k, v = qkv[0], qkv[1], qkv[2]
        phi = lambda t: torch.where(t > 0, t + 1, torch.exp(t)) + 1e-6
        pq, pk = phi(q), phi(k)
        kv = torch.einsum("bhsd,bhse->bhde", pk, v)
        z = torch.einsum("bhsd->bhd", pk)
        num = torch.einsum("bhqd,bhde->bhqe", pq, kv)
        den = torch.einsum("bhqd,bhd->bhq", pq, z)[..., None] + 1e-6
        o = num / den
        return (lambda x, *d: x.permute(*d))(o, 0, 2, 1, 3).reshape(B, S, D) @ wo

    def _B_ref(x, w1, b1, w2, b2):
        y = _layernorm(x, axis=-1)
        h = _gelu(torch.einsum("bsd,df->bsf", y, w1) + b1)
        return torch.einsum("bsf,fd->bsd", h, w2) + b2

    x = A_x
    h = x + _A_ref(_layernorm(x, axis=-1), A_wqkv, A_wo)
    h2 = h + _B_ref(_layernorm(h, axis=-1), B_w1, B_b1, B_w2, B_b2)
    return h2
```

```asm
; @launch grid=(256,1,1) block=(256,1,1) lds=163840
.amdgcn_target "amdgcn-amd-amdhsa--gfx950"
.text
.globl sequential_preLN__linear_attn_block__mixer_channel_mlp__prompt_kernel
.p2align 8
.type sequential_preLN__linear_attn_block__mixer_channel_mlp__prompt_kernel,@function
sequential_preLN__linear_attn_block__mixer_channel_mlp__prompt_kernel:
    s_cmp_ge_u32 s2, 256
    s_cbranch_scc1 L_end
    s_load_dwordx2 s[4:5], s[0:1], 0
    s_load_dwordx2 s[8:9], s[0:1], 8
    s_mov_b32 s6, 2097152
    s_mov_b32 s7, 0x00020000
    s_mov_b32 s10, 1572864
    s_mov_b32 s11, 0x00020000
    v_and_b32 v1, 63, v0
    v_lshrrev_b32 v4, 6, v0
    s_nop 0
    v_readfirstlane_b32 s47, v4
    s_bfe_u32 s51, s2, 65538
    s_lshl_b32 s51, s51, 2
    s_bfe_u32 s44, s2, 0x20003
    s_add_u32 s51, s51, s44
    s_bfe_u32 s52, s2, 131072
    s_lshl_b32 s52, s52, 3
    s_lshr_b32 s44, s2, 5
    s_add_u32 s52, s52, s44
    v_lshrrev_b32 v4, 3, v1
    v_and_b32 v5, 7, v1
    v_xor_b32 v6, v4, v5
    v_lshlrev_b32 v6, 4, v6
    v_lshl_add_u32 v8, v4, 10, v6
    v_add_u32 v9, 7168, v8
    v_bfe_u32 v6, v1, 4, 1
    s_and_b32 s44, s47, 1
    s_lshl_b32 s44, s44, 1
    v_or_b32 v6, s44, v6
    v_lshrrev_b32 v7, 1, v5
    v_xor_b32 v6, v6, v7
    v_lshlrev_b32 v6, 5, v6
    v_and_b32 v7, 1, v1
    v_lshl_add_u32 v6, v7, 4, v6
    v_mul_u32_u24 v10, 3072, v4
    v_add_u32 v10, v10, v6
    v_add_u32 v11, 98304, v10
    s_lshl_b32 s54, s52, 16
    s_lshl_b32 s44, s47, 14
    s_add_u32 s54, s54, s44
    s_mul_i32 s55, s47, 24576
    s_lshl_b32 s44, s51, 7
    s_add_u32 s55, s55, s44
    s_lshl_b32 s56, s47, 10
    s_lshl_b32 s57, s47, 11
    s_lshl_b32 s58, s47, 12
    s_mul_i32 s62, s47, 6144
    s_add_u32 s59, s52, s51
    s_and_b32 s59, s59, 1
    s_mul_i32 s59, s59, 4
    s_bfe_u32 s44, s2, 131072
    s_add_u32 s59, s59, s44
    s_bfe_u32 s44, s2, 65538
    s_lshl_b32 s44, s44, 1
    s_add_u32 s59, s59, s44
    s_cmp_eq_u32 s51, 3
    s_cselect_b32 s59, s52, s59
    s_xor_b32 s63, s51, 0
    s_sub_u32 s63, s63, s51
    s_lshl_b32 s63, s63, 7
    s_waitcnt lgkmcnt(0)
    s_add_u32 s60, s59, 0
    s_and_b32 s60, s60, 7
    s_lshl_b32 s60, s60, 7
    s_add_u32 s60, s60, s54
    s_add_u32 m0, s57, 0
    s_nop 0
    buffer_load_dwordx4 v8, s[4:7], s60 offen offset:0 lds
    buffer_load_dwordx4 v9, s[4:7], s60 offen offset:1024 lds
    s_add_u32 s61, s59, 0
    s_and_b32 s61, s61, 7
    s_mul_i32 s61, s61, 196608
    s_add_u32 s61, s61, s55
    s_add_u32 s64, s61, s63
    s_add_u32 m0, s62, 65536
    s_nop 0
    buffer_load_dwordx4 v10, s[8:11], s64 offen offset:0 lds
    buffer_load_dwordx4 v10, s[8:11], s61 offen offset:1024 lds
    buffer_load_dwordx4 v10, s[8:11], s61 offen offset:2048 lds
    s_add_u32 m0, s62, 68608
    s_nop 0
    buffer_load_dwordx4 v11, s[8:11], s64 offen offset:0 lds
    buffer_load_dwordx4 v11, s[8:11], s61 offen offset:1024 lds
    buffer_load_dwordx4 v11, s[8:11], s61 offen offset:2048 lds
    s_load_dwordx2 s[12:13], s[0:1], 80
    s_load_dwordx2 s[16:17], s[0:1], 72
    s_load_dwordx2 s[20:21], s[0:1], 16
    s_load_dwordx2 s[24:25], s[0:1], 32
    s_load_dwordx2 s[28:29], s[0:1], 48
    s_load_dwordx2 s[32:33], s[0:1], 40
    s_load_dwordx2 s[36:37], s[0:1], 56
    s_load_dwordx2 s[40:41], s[0:1], 64
    s_add_u32 s60, s59, 1
    s_and_b32 s60, s60, 7
    s_lshl_b32 s60, s60, 7
    s_add_u32 s60, s60, s54
    s_add_u32 m0, s57, 8192
    s_nop 0
    buffer_load_dwordx4 v8, s[4:7], s60 offen offset:0 lds
    buffer_load_dwordx4 v9, s[4:7], s60 offen offset:1024 lds
    s_mov_b32 s14, 14696448
    s_mov_b32 s15, 0x00020000
    s_mov_b32 s18, 256
    s_mov_b32 s19, 0x00020000
    s_mov_b32 s22, 524288
    s_mov_b32 s23, 0x00020000
    s_mov_b32 s26, 1409024
    s_mov_b32 s27, 0x00020000
    s_mov_b32 s30, 1409024
    s_mov_b32 s31, 0x00020000
    s_mov_b32 s34, 2752
    s_mov_b32 s35, 0x00020000
    s_mov_b32 s38, 1024
    s_mov_b32 s39, 0x00020000
    s_mov_b32 s42, 2097152
    s_mov_b32 s43, 0x00020000
    s_getreg_b32 s72, hwreg(HW_REG_XCC_ID)
    s_and_b32 s72, s72, 15
    s_add_u32 s72, s72, 1
    s_bfe_u32 s48, s2, 0x30003
    s_and_b32 s49, s2, 3
    s_lshl_b32 s49, s49, 3
    s_and_b32 s44, s2, 4
    s_add_u32 s49, s49, s44
    s_lshr_b32 s44, s2, 6
    s_add_u32 s49, s49, s44
    s_lshl_b32 s50, s48, 2
    s_add_u32 s50, s50, s47
    s_lshl_b32 s53, s51, 2
    s_add_u32 s53, s53, s47
    s_lshl_b32 s65, s53, 11
    s_add_u32 s65, s65, 3538944
    s_lshl_b32 s66, s49, 12
    s_add_u32 s66, s66, 12025856
    v_lshlrev_b32 v2, 4, v1
    v_mov_b32 v44, 0
    v_mov_b32 v45, 0
    v_mov_b32 v46, 0
    v_mov_b32 v47, 0
    s_waitcnt lgkmcnt(0)
    s_mov_b32 s73, s2
    s_cmp_ge_u32 s73, 8
    s_cbranch_scc1 L_nozero
    s_lshl_b32 s44, s73, 2
    s_add_u32 s44, s44, s47
    s_lshl_b32 s44, s44, 11
    s_add_u32 s44, s44, 3538944
    buffer_store_dwordx4 v[44:47], v2, s[12:15], s44 offen sc1
    buffer_store_dwordx4 v[44:47], v2, s[12:15], s44 offen offset:1024 sc1
    s_sub_u32 s44, s44, 3538944
    s_lshr_b32 s44, s44, 1
    s_add_u32 s44, s44, 3604480
    buffer_store_dwordx4 v[44:47], v2, s[12:15], s44 offen sc1
L_nozero:
    s_cmp_lg_u32 s47, 1
    s_cbranch_scc1 L_nofl
    s_lshl_b32 s44, s48, 7
    s_add_u32 s44, s44, s66
    v_lshrrev_b32 v4, 2, v1
    v_lshlrev_b32 v4, 26, v4
    v_lshl_add_u32 v4, v1, 10, v4
    v_mov_b32 v5, s72
    buffer_store_dwordx4 v[44:47], v4, s[12:15], s44 offen sc1
    buffer_store_dword v5, v4, s[12:15], s44 offen offset:16 sc1
L_nofl:
    s_mov_b64 exec, 0
    s_cmp_eq_u32 s47, 0
    s_cbranch_scc1 L_hop0
    s_cmp_eq_u32 s47, 1
    s_cbranch_scc1 L_hop1
    s_cmp_eq_u32 s47, 2
    s_cbranch_scc1 L_hop2
L_back0:
    s_mov_b64 exec, -1
    v_lshrrev_b32 v4, 4, v1
    v_and_b32 v5, 7, v1
    v_xor_b32 v6, v4, v5
    v_lshlrev_b32 v6, 4, v6
    v_lshl_add_u32 v6, v5, 7, v6
    v_bfe_u32 v7, v1, 3, 1
    v_lshl_add_u32 v12, v7, 10, v6
    v_xor_b32 v13, 64, v12
    v_add_u32 v14, s57, v12
    v_add_u32 v15, s57, v13
    v_and_b32 v6, 1, v4
    v_lshl_or_b32 v6, v6, 1, v7
    v_xor_b32 v6, s47, v6
    v_lshlrev_b32 v6, 5, v6
    v_and_b32 v7, 3, v1
    v_lshl_add_u32 v6, v7, 3, v6
    v_bfe_u32 v7, v1, 2, 2
    v_lshl_add_u32 v6, v7, 7, v6
    v_mul_u32_u24 v7, 6144, v4
    v_add_u32 v6, v6, v7
    v_add_u32 v16, 65536, v6
    s_mov_b32 s70, 0x3f803f80
    v_mov_b32 v40, s70
    v_mov_b32 v41, s70
    v_mov_b32 v42, s70
    v_mov_b32 v43, s70
    v_lshlrev_b32 v177, 7, v1
    v_max_u32 v176, 10, v1
    v_subrev_u32 v176, 10, v176
    v_lshl_add_u32 v176, v176, 24, v177
    v_lshrrev_b32 v182, 2, v1
    v_lshl_add_u32 v182, v182, 24, v177
    v_lshrrev_b32 v47, 2, v1
    v_lshl_add_u32 v177, v47, 24, v177
    s_lshl_b32 s44, s47, 1
    v_xor_b32 v6, s44, v5
    v_lshlrev_b32 v6, 4, v6
    v_lshl_add_u32 v6, v5, 7, v6
    v_bfe_u32 v7, v1, 3, 2
    v_lshl_add_u32 v6, v7, 10, v6
    v_lshrrev_b32 v7, 5, v1
    v_lshl_add_u32 v6, v7, 3, v6
    v_add_u32 v18, 147456, v6
    v_xor_b32 v19, 16, v18
    s_mov_b32 s71, 0x3727c5ac
    v_lshlrev_b32 v21, 5, v1
    s_mul_i32 s44, s47, 1536
    s_add_u32 s44, s44, 157696
    v_add_u32 v34, s44, v2
    v_lshl_add_u32 v35, v4, 4, s44
    v_lshlrev_b32 v37, 2, v1
    v_add_u32 v36, s44, v37
    v_and_b32 v5, 15, v1
    v_lshl_add_u32 v38, v5, 2, s44
    v_bfe_u32 v6, v1, 2, 1
    v_lshlrev_b32 v6, 10, v6
    v_bfe_u32 v5, v1, 3, 1
    v_lshl_add_u32 v6, v5, 9, v6
    v_and_b32 v5, 3, v1
    v_lshl_add_u32 v6, v5, 2, v6
    v_add_u32 v6, 256, v6
    v_lshrrev_b32 v5, 4, v1
    v_lshl_add_u32 v39, v5, 28, v6
    s_mov_b32 s74, s2
    s_lshr_b32 s45, s74, 3
    s_and_b32 s44, s74, 7
    s_lshl_b32 s67, s45, 16
    s_lshl_b32 s69, s44, 7
    s_add_u32 s67, s67, s69
    s_lshl_b32 s69, s47, 14
    s_add_u32 s67, s67, s69
    s_mul_i32 s69, s44, 180224
    s_lshl_b32 s45, s45, 11
    s_add_u32 s69, s69, s45
    s_mul_i32 s45, s47, 45056
    s_add_u32 s69, s69, s45
    s_add_u32 s61, s59, 1
    s_and_b32 s61, s61, 7
    s_mul_i32 s61, s61, 196608
    s_add_u32 s61, s61, s55
    s_add_u32 s64, s61, s63
    s_add_u32 m0, s62, 90112
    s_nop 0
    buffer_load_dwordx4 v10, s[8:11], s64 offen offset:0 lds
    buffer_load_dwordx4 v10, s[8:11], s61 offen offset:1024 lds
    s_add_u32 s69, s69, 2097152
    s_cmp_lt_u32 s74, 176
    s_cselect_b32 s69, s69, 2146435072
    s_cselect_b32 s67, s67, 2146435072
    v_lshlrev_b32 v4, 10, v7
    v_bfe_u32 v5, v1, 2, 2
    v_lshl_add_u32 v4, v5, 7, v4
    v_bfe_u32 v5, v1, 3, 1
    v_lshlrev_b32 v5, 1, v5
    v_bfe_u32 v6, v1, 4, 1
    v_or_b32 v5, v5, v6
    v_lshl_add_u32 v4, v5, 5, v4
    v_and_b32 v5, 3, v1
    v_lshl_add_u32 v4, v5, 3, v4
    s_add_u32 s45, s57, 139264
    v_add_u32 v32, s45, v4
    v_xor_b32 v33, 64, v32
    v_lshrrev_b32 v4, 3, v1
    v_lshlrev_b32 v6, 1, v6
    v_bfe_u32 v5, v1, 1, 2
    v_xor_b32 v5, v5, v6
    v_lshlrev_b32 v5, 5, v5
    v_and_b32 v6, 1, v1
    v_lshl_add_u32 v5, v6, 4, v5
    v_lshl_add_u32 v178, v4, 10, v5
    v_add_u32 v179, 7168, v178
    s_lshr_b32 s44, s47, 1
    s_lshl_b32 s44, s44, 5
    v_xor_b32 v5, s44, v5
    v_mul_u32_u24 v4, 2752, v4
    v_add_u32 v3, v4, v5
    s_lshl_b32 s68, s49, 16
    s_lshl_b32 s44, s47, 14
    s_add_u32 s68, s68, s44
    s_lshl_b32 s44, s48, 7
    s_add_u32 s68, s68, s44
    s_mov_b32 s76, 0xaaaaaaaa
    s_mov_b32 s77, 0xaaaaaaaa
    s_mov_b32 s78, 0xcccccccc
    s_mov_b32 s79, 0xcccccccc
    v_and_b32 v4, 15, v1
    v_lshlrev_b32 v175, 3, v4
    v_lshlrev_b32 v4, 2, v4
    s_lshl_b32 s44, s47, 6
    v_add_u32 v172, s44, v4
    v_lshlrev_b32 v173, 1, v172
    v_lshrrev_b32 v174, 4, v1
    v_lshlrev_b32 v174, 4, v174
    v_add_u32 v172, 155648, v172
    v_add_u32 v173, 155648, v173
    v_add_u32 v174, 155648, v174
    v_add_u32 v175, 155648, v175
    buffer_load_dwordx4 v10, s[8:11], s61 offen offset:2048 lds
    s_add_u32 m0, s62, 93184
    s_nop 0
    buffer_load_dwordx4 v11, s[8:11], s64 offen offset:0 lds
    buffer_load_dwordx4 v11, s[8:11], s61 offen offset:1024 lds
    buffer_load_dwordx4 v11, s[8:11], s61 offen offset:2048 lds
    s_branch L_main
    .p2align 12
L_main:
L_hop0:
    s_cbranch_execz L_back0
    s_waitcnt vmcnt(8)
    s_barrier
    s_add_u32 s60, s59, 2
    s_and_b32 s60, s60, 7
    s_lshl_b32 s60, s60, 7
    s_add_u32 s60, s60, s54
    s_add_u32 m0, s57, 16384
    s_nop 0
    buffer_load_dwordx4 v8, s[4:7], s60 offen offset:0 lds
    ds_read_b64_tr_b16 v[48:49], v16 offset:1024
    ds_read_b64_tr_b16 v[50:51], v16 offset:1536
    ds_read_b64_tr_b16 v[52:53], v16 offset:2048
    buffer_load_dwordx4 v9, s[4:7], s60 offen offset:1024 lds
    ds_read_b64_tr_b16 v[54:55], v16 offset:2560
    ds_read_b64_tr_b16 a[192:193], v16 offset:0
    ds_read_b64_tr_b16 a[194:195], v16 offset:512
    s_add_u32 s61, s59, 2
    s_and_b32 s61, s61, 7
    s_mul_i32 s61, s61, 196608
    s_add_u32 s61, s61, s55
    s_add_u32 s64, s61, s63
    s_add_u32 m0, s62, 114688
    s_nop 0
    buffer_load_dwordx4 v10, s[8:11], s64 offen offset:0 lds
    ds_read_b128 a[160:163], v12 offset:0
    ds_read_b128 a[164:167], v12 offset:2048
    ds_read_b128 a[168:171], v12 offset:4096
    buffer_load_dwordx4 v10, s[8:11], s61 offen offset:1024 lds
    ds_read_b128 a[172:175], v12 offset:6144
    ds_read_b64_tr_b16 v[56:57], v16 offset:4096
    ds_read_b64_tr_b16 v[58:59], v16 offset:4608
    buffer_load_dwordx4 v10, s[8:11], s61 offen offset:2048 lds
    ds_read_b64_tr_b16 v[60:61], v16 offset:5120
    ds_read_b64_tr_b16 v[62:63], v16 offset:5632
    ds_read_b64_tr_b16 a[196:197], v16 offset:3072
    s_add_u32 m0, s62, 117760
    s_nop 0
    buffer_load_dwordx4 v11, s[8:11], s64 offen offset:0 lds
    ds_read_b64_tr_b16 a[198:199], v16 offset:3584
    ds_read_b128 a[176:179], v13 offset:0
    ds_read_b128 a[180:183], v13 offset:2048
    buffer_load_dwordx4 v11, s[8:11], s61 offen offset:1024 lds
    ds_read_b128 a[184:187], v13 offset:4096
    ds_read_b128 a[188:191], v13 offset:6144
    buffer_load_dwordx4 v11, s[8:11], s61 offen offset:2048 lds
    s_waitcnt vmcnt(8)
    s_waitcnt lgkmcnt(0)
    s_barrier
    v_mfma_f32_16x16x32_bf16 v[96:99], a[160:163], v[48:51], 0
    ds_read_b128 v[184:187], v14 offset:0
    s_add_u32 s61, s59, 3
    v_mfma_f32_16x16x32_bf16 v[112:115], a[160:163], v[52:55], 0
    ds_read_b128 v[188:191], v15 offset:0
    s_and_b32 s61, s61, 7
    v_mfma_f32_16x16x32_bf16 v[100:103], a[164:167], v[48:51], 0
    ds_read_b128 v[192:195], v14 offset:8192
    s_mul_i32 s61, s61, 196608
    v_mfma_f32_16x16x32_bf16 v[116:119], a[164:167], v[52:55], 0
    ds_read_b128 v[196:199], v15 offset:8192
    s_add_u32 s61, s61, s55
    v_mfma_f32_16x16x32_bf16 v[104:107], a[168:171], v[48:51], 0
    ds_read_b64_tr_b16 v[64:65], v16 offset:25600
    s_add_u32 s64, s61, s63
    v_mfma_f32_16x16x32_bf16 v[120:123], a[168:171], v[52:55], 0
    ds_read_b64_tr_b16 v[66:67], v16 offset:26112
    s_add_u32 m0, s62, 65536
    v_mfma_f32_16x16x32_bf16 v[108:111], a[172:175], v[48:51], 0
    buffer_load_dwordx4 v10, s[8:11], s64 offen offset:0 lds
    v_mfma_f32_16x16x32_bf16 v[124:127], a[172:175], v[52:55], 0
    ds_read_b64_tr_b16 v[68:69], v16 offset:26624
    v_mfma_f32_16x16x32_bf16 v[144:147], v[40:43], v[48:51], 0
    ds_read_b64_tr_b16 v[70:71], v16 offset:27136
    v_mfma_f32_16x16x32_bf16 v[148:151], v[40:43], v[52:55], 0
    ds_read_b64_tr_b16 a[232:233], v16 offset:24576
    v_mfma_f32_16x16x32_bf16 v[96:99], a[176:179], v[56:59], v[96:99]
    buffer_load_dwordx4 v10, s[8:11], s61 offen offset:1024 lds
    v_mfma_f32_16x16x32_bf16 v[112:115], a[176:179], v[60:63], v[112:115]
    ds_read_b64_tr_b16 a[234:235], v16 offset:25088
    v_mfma_f32_16x16x32_bf16 v[100:103], a[180:183], v[56:59], v[100:103]
    ds_read_b128 a[200:203], v12 offset:8192
    v_mfma_f32_16x16x32_bf16 v[116:119], a[180:183], v[60:63], v[116:119]
    ds_read_b128 a[204:207], v12 offset:10240
    v_mfma_f32_16x16x32_bf16 v[104:107], a[184:187], v[56:59], v[104:107]
    buffer_load_dwordx4 v10, s[8:11], s61 offen offset:2048 lds
    v_mfma_f32_16x16x32_bf16 v[120:123], a[184:187], v[60:63], v[120:123]
    ds_read_b128 a[208:211], v12 offset:12288
    s_add_u32 m0, s62, 68608
    v_mfma_f32_16x16x32_bf16 v[108:111], a[188:191], v[56:59], v[108:111]
    ds_read_b128 a[212:215], v12 offset:14336
    v_mfma_f32_16x16x32_bf16 v[124:127], a[188:191], v[60:63], v[124:127]
    ds_read_b64_tr_b16 v[72:73], v16 offset:28672
    v_mfma_f32_16x16x32_bf16 v[144:147], v[40:43], v[56:59], v[144:147]
    buffer_load_dwordx4 v11, s[8:11], s64 offen offset:0 lds
    v_mfma_f32_16x16x32_bf16 v[148:151], v[40:43], v[60:63], v[148:151]
    ds_read_b64_tr_b16 v[74:75], v16 offset:29184
    v_mfma_f32_16x16x32_bf16 v[128:131], a[192:195], a[160:163], 0
    ds_read_b64_tr_b16 v[76:77], v16 offset:29696
    v_mfma_f32_16x16x32_bf16 v[132:135], a[192:195], a[164:167], 0
    ds_read_b64_tr_b16 v[78:79], v16 offset:30208
    v_mfma_f32_16x16x32_bf16 v[136:139], a[192:195], a[168:171], 0
    buffer_load_dwordx4 v11, s[8:11], s61 offen offset:1024 lds
    v_mfma_f32_16x16x32_bf16 v[140:143], a[192:195], a[172:175], 0
    ds_read_b64_tr_b16 a[236:237], v16 offset:27648
    v_mfma_f32_16x16x32_bf16 v[152:155], a[192:195], v[40:43], 0
    ds_read_b64_tr_b16 a[238:239], v16 offset:28160
    v_mfma_f32_16x16x32_bf16 v[128:131], a[196:199], a[176:179], v[128:131]
    ds_read_b128 a[216:219], v13 offset:8192
    v_mfma_f32_16x16x32_bf16 v[132:135], a[196:199], a[180:183], v[132:135]
    buffer_load_dwordx4 v11, s[8:11], s61 offen offset:2048 lds
    v_mfma_f32_16x16x32_bf16 v[136:139], a[196:199], a[184:187], v[136:139]
    ds_read_b128 a[220:223], v13 offset:10240
    s_add_u32 s60, s59, 3
    v_mfma_f32_16x16x32_bf16 v[140:143], a[196:199], a[188:191], v[140:143]
    ds_read_b128 a[224:227], v13 offset:12288
    s_and_b32 s60, s60, 7
    v_mfma_f32_16x16x32_bf16 v[152:155], a[196:199], v[40:43], v[152:155]
    ds_read_b128 a[228:231], v13 offset:14336
    s_lshl_b32 s60, s60, 7
    s_waitcnt lgkmcnt(15)
    v_mfma_f32_16x16x32_bf16 v[156:159], v[184:187], v[40:43], 0
    s_add_u32 s60, s60, s54
    s_add_u32 m0, s57, 24576
    v_mfma_f32_16x16x32_bf16 v[160:163], v[184:187], v[184:187], 0
    buffer_load_dwordx4 v8, s[4:7], s60 offen offset:0 lds
    v_mfma_f32_16x16x32_bf16 v[156:159], v[188:191], v[40:43], v[156:159]
    v_mfma_f32_16x16x32_bf16 v[160:163], v[188:191], v[188:191], v[160:163]
    v_mfma_f32_16x16x32_bf16 v[156:159], v[192:195], v[40:43], v[156:159]
    v_mfma_f32_16x16x32_bf16 v[160:163], v[192:195], v[192:195], v[160:163]
    buffer_load_dwordx4 v9, s[4:7], s60 offen offset:1024 lds
    v_mfma_f32_16x16x32_bf16 v[156:159], v[196:199], v[40:43], v[156:159]
    v_mfma_f32_16x16x32_bf16 v[160:163], v[196:199], v[196:199], v[160:163]
    s_waitcnt vmcnt(8)
    s_waitcnt lgkmcnt(0)
    s_barrier
    s_cmp_ge_u32 s73, 8
    s_cbranch_scc1 L_noroot
    s_cmp_lg_u32 s47, 0
    s_cbranch_scc1 L_noroot
    s_lshl_b32 s46, s73, 5
    v_lshlrev_b32_e64 v44, 24, v1
    v_mov_b32 v45, 1
    buffer_store_dword v45, v44, s[16:19], s46 offen sc1
L_noroot:
    v_mfma_f32_16x16x32_bf16 v[96:99], a[200:203], v[64:67], v[96:99]
    ds_read_b128 v[184:187], v14 offset:16384
    s_add_u32 s61, s59, 4
    v_mfma_f32_16x16x32_bf16 v[112:115], a[200:203], v[68:71], v[112:115]
    ds_read_b128 v[188:191], v15 offset:16384
    s_and_b32 s61, s61, 7
    v_mfma_f32_16x16x32_bf16 v[100:103], a[204:207], v[64:67], v[100:103]
    ds_read_b64_tr_b16 v[48:49], v16 offset:50176
    s_mul_i32 s61, s61, 196608
    v_mfma_f32_16x16x32_bf16 v[116:119], a[204:207], v[68:71], v[116:119]
    ds_read_b64_tr_b16 v[50:51], v16 offset:50688
    s_add_u32 s61, s61, s55
    v_mfma_f32_16x16x32_bf16 v[104:107], a[208:211], v[64:67], v[104:107]
    ds_read_b64_tr_b16 v[52:53], v16 offset:51200
    s_add_u32 s64, s61, s63
    v_mfma_f32_16x16x32_bf16 v[120:123], a[208:211], v[68:71], v[120:123]
    ds_read_b64_tr_b16 v[54:55], v16 offset:51712
    s_add_u32 m0, s62, 90112
    v_mfma_f32_16x16x32_bf16 v[108:111], a[212:215], v[64:67], v[108:111]
    buffer_load_dwordx4 v10, s[8:11], s64 offen offset:0 lds
    v_mfma_f32_16x16x32_bf16 v[124:127], a[212:215], v[68:71], v[124:127]
    ds_read_b64_tr_b16 a[32:33], v16 offset:49152
    v_mfma_f32_16x16x32_bf16 v[144:147], v[40:43], v[64:67], v[144:147]
    ds_read_b64_tr_b16 a[34:35], v16 offset:49664
    v_mfma_f32_16x16x32_bf16 v[148:151], v[40:43], v[68:71], v[148:151]
    buffer_load_dwordx4 v10, s[8:11], s61 offen offset:1024 lds
    v_mfma_f32_16x16x32_bf16 v[96:99], a[216:219], v[72:75], v[96:99]
    ds_read_b128 a[0:3], v12 offset:16384
    v_mfma_f32_16x16x32_bf16 v[112:115], a[216:219], v[76:79], v[112:115]
    ds_read_b128 a[4:7], v12 offset:18432
    v_mfma_f32_16x16x32_bf16 v[100:103], a[220:223], v[72:75], v[100:103]
    buffer_load_dwordx4 v10, s[8:11], s61 offen offset:2048 lds
    v_mfma_f32_16x16x32_bf16 v[116:119], a[220:223], v[76:79], v[116:119]
    ds_read_b128 a[8:11], v12 offset:20480
    s_add_u32 m0, s62, 93184
    v_mfma_f32_16x16x32_bf16 v[104:107], a[224:227], v[72:75], v[104:107]
    ds_read_b128 a[12:15], v12 offset:22528
    v_mfma_f32_16x16x32_bf16 v[120:123], a[224:227], v[76:79], v[120:123]
    buffer_load_dwordx4 v11, s[8:11], s64 offen offset:0 lds
    v_mfma_f32_16x16x32_bf16 v[108:111], a[228:231], v[72:75], v[108:111]
    ds_read_b64_tr_b16 v[56:57], v16 offset:53248
    v_mfma_f32_16x16x32_bf16 v[124:127], a[228:231], v[76:79], v[124:127]
    ds_read_b64_tr_b16 v[58:59], v16 offset:53760
    v_mfma_f32_16x16x32_bf16 v[144:147], v[40:43], v[72:75], v[144:147]
    buffer_load_dwordx4 v11, s[8:11], s61 offen offset:1024 lds
    v_mfma_f32_16x16x32_bf16 v[148:151], v[40:43], v[76:79], v[148:151]
    ds_read_b64_tr_b16 v[60:61], v16 offset:54272
    v_mfma_f32_16x16x32_bf16 v[128:131], a[232:235], a[200:203], v[128:131]
    ds_read_b64_tr_b16 v[62:63], v16 offset:54784
    v_mfma_f32_16x16x32_bf16 v[132:135], a[232:235], a[204:207], v[132:135]
    buffer_load_dwordx4 v11, s[8:11], s61 offen offset:2048 lds
    v_mfma_f32_16x16x32_bf16 v[136:139], a[232:235], a[208:211], v[136:139]
    ds_read_b64_tr_b16 a[36:37], v16 offset:52224
    s_add_u32 s60, s59, 4
    v_mfma_f32_16x16x32_bf16 v[140:143], a[232:235], a[212:215], v[140:143]
    ds_read_b64_tr_b16 a[38:39], v16 offset:52736
    s_and_b32 s60, s60, 7
    v_mfma_f32_16x16x32_bf16 v[152:155], a[232:235], v[40:43], v[152:155]
    ds_read_b128 a[16:19], v13 offset:16384
    s_lshl_b32 s60, s60, 7
    v_mfma_f32_16x16x32_bf16 v[128:131], a[236:239], a[216:219], v[128:131]
    ds_read_b128 a[20:23], v13 offset:18432
    s_add_u32 s60, s60, s54
    v_mfma_f32_16x16x32_bf16 v[132:135], a[236:239], a[220:223], v[132:135]
    ds_read_b128 a[24:27], v13 offset:20480
    s_add_u32 m0, s57, 32768
    v_mfma_f32_16x16x32_bf16 v[136:139], a[236:239], a[224:227], v[136:139]
    buffer_load_dwordx4 v8, s[4:7], s60 offen offset:0 lds
    v_mfma_f32_16x16x32_bf16 v[140:143], a[236:239], a[228:231], v[140:143]
    ds_read_b128 a[28:31], v13 offset:22528
    v_mfma_f32_16x16x32_bf16 v[152:155], a[236:239], v[40:43], v[152:155]
    s_waitcnt lgkmcnt(15)
    v_mfma_f32_16x16x32_bf16 v[156:159], v[184:187], v[40:43], v[156:159]
    buffer_load_dwordx4 v9, s[4:7], s60 offen offset:1024 lds
    v_mfma_f32_16x16x32_bf16 v[160:163], v[184:187], v[184:187], v[160:163]
    s_add_u32 s60, s59, 5
    s_and_b32 s60, s60, 7
    s_lshl_b32 s60, s60, 7
    v_mfma_f32_16x16x32_bf16 v[156:159], v[188:191], v[40:43], v[156:159]
    s_add_u32 s60, s60, s54
    s_add_u32 m0, s57, 40960
    v_mfma_f32_16x16x32_bf16 v[160:163], v[188:191], v[188:191], v[160:163]
    buffer_load_dwordx4 v8, s[4:7], s60 offen offset:0 lds
    buffer_load_dwordx4 v9, s[4:7], s60 offen offset:1024 lds
    s_waitcnt vmcnt(12)
    s_waitcnt vmcnt(10)
    s_waitcnt lgkmcnt(0)
    s_barrier
    v_mfma_f32_16x16x32_bf16 v[96:99], a[0:3], v[48:51], v[96:99]
    ds_read_b128 v[184:187], v14 offset:24576
    s_add_u32 s61, s59, 5
    v_mfma_f32_16x16x32_bf16 v[112:115], a[0:3], v[52:55], v[112:115]
    ds_read_b128 v[188:191], v15 offset:24576
    s_and_b32 s61, s61, 7
    v_mfma_f32_16x16x32_bf16 v[100:103], a[4:7], v[48:51], v[100:103]
    ds_read_b64_tr_b16 v[64:65], v16 offset:1024
    s_mul_i32 s61, s61, 196608
    v_mfma_f32_16x16x32_bf16 v[116:119], a[4:7], v[52:55], v[116:119]
    ds_read_b64_tr_b16 v[66:67], v16 offset:1536
    s_add_u32 s61, s61, s55
    v_mfma_f32_16x16x32_bf16 v[104:107], a[8:11], v[48:51], v[104:107]
    ds_read_b64_tr_b16 v[68:69], v16 offset:2048
    s_add_u32 s64, s61, s63
    v_mfma_f32_16x16x32_bf16 v[120:123], a[8:11], v[52:55], v[120:123]
    ds_read_b64_tr_b16 v[70:71], v16 offset:2560
    s_add_u32 m0, s62, 114688
    v_mfma_f32_16x16x32_bf16 v[108:111], a[12:15], v[48:51], v[108:111]
    buffer_load_dwordx4 v10, s[8:11], s64 offen offset:0 lds
    v_mfma_f32_16x16x32_bf16 v[124:127], a[12:15], v[52:55], v[124:127]
    ds_read_b64_tr_b16 a[72:73], v16 offset:0
    v_mfma_f32_16x16x32_bf16 v[144:147], v[40:43], v[48:51], v[144:147]
    ds_read_b64_tr_b16 a[74:75], v16 offset:512
    v_mfma_f32_16x16x32_bf16 v[148:151], v[40:43], v[52:55], v[148:151]
    ds_read_b128 a[40:43], v12 offset:24576
    v_mfma_f32_16x16x32_bf16 v[96:99], a[16:19], v[56:59], v[96:99]
    buffer_load_dwordx4 v10, s[8:11], s61 offen offset:1024 lds
    v_mfma_f32_16x16x32_bf16 v[112:115], a[16:19], v[60:63], v[112:115]
    ds_read_b128 a[44:47], v12 offset:26624
    v_mfma_f32_16x16x32_bf16 v[100:103], a[20:23], v[56:59], v[100:103]
    ds_read_b128 a[48:51], v12 offset:28672
    v_mfma_f32_16x16x32_bf16 v[116:119], a[20:23], v[60:63], v[116:119]
    ds_read_b128 a[52:55], v12 offset:30720
    v_mfma_f32_16x16x32_bf16 v[104:107], a[24:27], v[56:59], v[104:107]
    buffer_load_dwordx4 v10, s[8:11], s61 offen offset:2048 lds
    v_mfma_f32_16x16x32_bf16 v[120:123], a[24:27], v[60:63], v[120:123]
    ds_read_b64_tr_b16 v[72:73], v16 offset:4096
    s_add_u32 m0, s62, 117760
    v_mfma_f32_16x16x32_bf16 v[108:111], a[28:31], v[56:59], v[108:111]
    ds_read_b64_tr_b16 v[74:75], v16 offset:4608
    v_mfma_f32_16x16x32_bf16 v[124:127], a[28:31], v[60:63], v[124:127]
    ds_read_b64_tr_b16 v[76:77], v16 offset:5120
    v_mfma_f32_16x16x32_bf16 v[144:147], v[40:43], v[56:59], v[144:147]
    buffer_load_dwordx4 v11, s[8:11], s64 offen offset:0 lds
    v_mfma_f32_16x16x32_bf16 v[148:151], v[40:43], v[60:63], v[148:151]
    ds_read_b64_tr_b16 v[78:79], v16 offset:5632
    v_mfma_f32_16x16x32_bf16 v[128:131], a[32:35], a[0:3], v[128:131]
    ds_read_b64_tr_b16 a[76:77], v16 offset:3072
    v_mfma_f32_16x16x32_bf16 v[132:135], a[32:35], a[4:7], v[132:135]
    ds_read_b64_tr_b16 a[78:79], v16 offset:3584
    v_mfma_f32_16x16x32_bf16 v[136:139], a[32:35], a[8:11], v[136:139]
    buffer_load_dwordx4 v11, s[8:11], s61 offen offset:1024 lds
    v_mfma_f32_16x16x32_bf16 v[140:143], a[32:35], a[12:15], v[140:143]
    ds_read_b128 a[56:59], v13 offset:24576
    v_mfma_f32_16x16x32_bf16 v[152:155], a[32:35], v[40:43], v[152:155]
    ds_read_b128 a[60:63], v13 offset:26624
    v_mfma_f32_16x16x32_bf16 v[128:131], a[36:39], a[16:19], v[128:131]
    ds_read_b128 a[64:67], v13 offset:28672
    v_mfma_f32_16x16x32_bf16 v[132:135], a[36:39], a[20:23], v[132:135]
    buffer_load_dwordx4 v11, s[8:11], s61 offen offset:2048 lds
    v_mfma_f32_16x16x32_bf16 v[136:139], a[36:39], a[24:27], v[136:139]
    ds_read_b128 a[68:71], v13 offset:30720
    s_add_u32 s60, s59, 6
    v_mfma_f32_16x16x32_bf16 v[140:143], a[36:39], a[28:31], v[140:143]
    s_and_b32 s60, s60, 7
    s_lshl_b32 s60, s60, 7
    s_add_u32 s60, s60, s54
    v_mfma_f32_16x16x32_bf16 v[152:155], a[36:39], v[40:43], v[152:155]
    s_add_u32 m0, s57, 49152
    s_waitcnt lgkmcnt(15)
    v_mfma_f32_16x16x32_bf16 v[156:159], v[184:187], v[40:43], v[156:159]
    buffer_load_dwordx4 v8, s[4:7], s60 offen offset:0 lds
    v_mfma_f32_16x16x32_bf16 v[160:163], v[184:187], v[184:187], v[160:163]
    v_mfma_f32_16x16x32_bf16 v[156:159], v[188:191], v[40:43], v[156:159]
    v_mfma_f32_16x16x32_bf16 v[160:163], v[188:191], v[188:191], v[160:163]
    buffer_load_dwordx4 v9, s[4:7], s60 offen offset:1024 lds
    s_waitcnt vmcnt(12)
    s_waitcnt vmcnt(10)
    s_waitcnt vmcnt(8)
    s_waitcnt lgkmcnt(0)
    s_barrier
    v_mfma_f32_16x16x32_bf16 v[96:99], a[40:43], v[64:67], v[96:99]
    ds_read_b128 v[184:187], v14 offset:32768
    s_add_u32 s61, s59, 6
    v_mfma_f32_16x16x32_bf16 v[112:115], a[40:43], v[68:71], v[112:115]
    ds_read_b128 v[188:191], v15 offset:32768
    s_and_b32 s61, s61, 7
    v_mfma_f32_16x16x32_bf16 v[100:103], a[44:47], v[64:67], v[100:103]
    ds_read_b128 v[192:195], v14 offset:40960
    s_mul_i32 s61, s61, 196608
    v_mfma_f32_16x16x32_bf16 v[116:119], a[44:47], v[68:71], v[116:119]
    ds_read_b128 v[196:199], v15 offset:40960
    s_add_u32 s61, s61, s55
    v_mfma_f32_16x16x32_bf16 v[104:107], a[48:51], v[64:67], v[104:107]
    ds_read_b64_tr_b16 v[48:49], v16 offset:25600
    s_add_u32 s64, s61, s63
    v_mfma_f32_16x16x32_bf16 v[120:123], a[48:51], v[68:71], v[120:123]
    ds_read_b64_tr_b16 v[50:51], v16 offset:26112
    s_add_u32 m0, s62, 65536
    v_mfma_f32_16x16x32_bf16 v[108:111], a[52:55], v[64:67], v[108:111]
    buffer_load_dwordx4 v10, s[8:11], s64 offen offset:0 lds
    v_mfma_f32_16x16x32_bf16 v[124:127], a[52:55], v[68:71], v[124:127]
    ds_read_b64_tr_b16 v[52:53], v16 offset:26624
    v_mfma_f32_16x16x32_bf16 v[144:147], v[40:43], v[64:67], v[144:147]
    ds_read_b64_tr_b16 v[54:55], v16 offset:27136
    v_mfma_f32_16x16x32_bf16 v[148:151], v[40:43], v[68:71], v[148:151]
    ds_read_b64_tr_b16 a[112:113], v16 offset:24576
    v_mfma_f32_16x16x32_bf16 v[96:99], a[56:59], v[72:75], v[96:99]
    buffer_load_dwordx4 v10, s[8:11], s61 offen offset:1024 lds
    v_mfma_f32_16x16x32_bf16 v[112:115], a[56:59], v[76:79], v[112:115]
    ds_read_b64_tr_b16 a[114:115], v16 offset:25088
    v_mfma_f32_16x16x32_bf16 v[100:103], a[60:63], v[72:75], v[100:103]
    ds_read_b128 a[80:83], v12 offset:32768
    v_mfma_f32_16x16x32_bf16 v[116:119], a[60:63], v[76:79], v[116:119]
    ds_read_b128 a[84:87], v12 offset:34816
    v_mfma_f32_16x16x32_bf16 v[104:107], a[64:67], v[72:75], v[104:107]
    buffer_load_dwordx4 v10, s[8:11], s61 offen offset:2048 lds
    v_mfma_f32_16x16x32_bf16 v[120:123], a[64:67], v[76:79], v[120:123]
    ds_read_b128 a[88:91], v12 offset:36864
    s_add_u32 m0, s62, 68608
    v_mfma_f32_16x16x32_bf16 v[108:111], a[68:71], v[72:75], v[108:111]
    ds_read_b128 a[92:95], v12 offset:38912
    v_mfma_f32_16x16x32_bf16 v[124:127], a[68:71], v[76:79], v[124:127]
    ds_read_b64_tr_b16 v[56:57], v16 offset:28672
    v_mfma_f32_16x16x32_bf16 v[144:147], v[40:43], v[72:75], v[144:147]
    buffer_load_dwordx4 v11, s[8:11], s64 offen offset:0 lds
    v_mfma_f32_16x16x32_bf16 v[148:151], v[40:43], v[76:79], v[148:151]
    ds_read_b64_tr_b16 v[58:59], v16 offset:29184
    v_mfma_f32_16x16x32_bf16 v[128:131], a[72:75], a[40:43], v[128:131]
    ds_read_b64_tr_b16 v[60:61], v16 offset:29696
    v_mfma_f32_16x16x32_bf16 v[132:135], a[72:75], a[44:47], v[132:135]
    ds_read_b64_tr_b16 v[62:63], v16 offset:30208
    v_mfma_f32_16x16x32_bf16 v[136:139], a[72:75], a[48:51], v[136:139]
    buffer_load_dwordx4 v11, s[8:11], s61 offen offset:1024 lds
    v_mfma_f32_16x16x32_bf16 v[140:143], a[72:75], a[52:55], v[140:143]
    ds_read_b64_tr_b16 a[116:117], v16 offset:27648
    v_mfma_f32_16x16x32_bf16 v[152:155], a[72:75], v[40:43], v[152:155]
    ds_read_b64_tr_b16 a[118:119], v16 offset:28160
    v_mfma_f32_16x16x32_bf16 v[128:131], a[76:79], a[56:59], v[128:131]
    ds_read_b128 a[96:99], v13 offset:32768
    v_mfma_f32_16x16x32_bf16 v[132:135], a[76:79], a[60:63], v[132:135]
    buffer_load_dwordx4 v11, s[8:11], s61 offen offset:2048 lds
    v_mfma_f32_16x16x32_bf16 v[136:139], a[76:79], a[64:67], v[136:139]
    ds_read_b128 a[100:103], v13 offset:34816
    s_add_u32 s60, s59, 7
    v_mfma_f32_16x16x32_bf16 v[140:143], a[76:79], a[68:71], v[140:143]
    ds_read_b128 a[104:107], v13 offset:36864
    s_and_b32 s60, s60, 7
    v_mfma_f32_16x16x32_bf16 v[152:155], a[76:79], v[40:43], v[152:155]
    ds_read_b128 a[108:111], v13 offset:38912
    s_lshl_b32 s60, s60, 7
    s_waitcnt lgkmcnt(15)
    v_mfma_f32_16x16x32_bf16 v[156:159], v[184:187], v[40:43], v[156:159]
    s_add_u32 s60, s60, s54
    s_add_u32 m0, s57, 57344
    v_mfma_f32_16x16x32_bf16 v[160:163], v[184:187], v[184:187], v[160:163]
    buffer_load_dwordx4 v8, s[4:7], s60 offen offset:0 lds
    v_mfma_f32_16x16x32_bf16 v[156:159], v[188:191], v[40:43], v[156:159]
    v_mfma_f32_16x16x32_bf16 v[160:163], v[188:191], v[188:191], v[160:163]
    v_mfma_f32_16x16x32_bf16 v[156:159], v[192:195], v[40:43], v[156:159]
    v_mfma_f32_16x16x32_bf16 v[160:163], v[192:195], v[192:195], v[160:163]
    buffer_load_dwordx4 v9, s[4:7], s60 offen offset:1024 lds
    v_mfma_f32_16x16x32_bf16 v[156:159], v[196:199], v[40:43], v[156:159]
    v_mfma_f32_16x16x32_bf16 v[160:163], v[196:199], v[196:199], v[160:163]
    s_waitcnt vmcnt(10)
    s_waitcnt vmcnt(8)
    s_waitcnt lgkmcnt(0)
    s_barrier
    v_mfma_f32_16x16x32_bf16 v[96:99], a[80:83], v[48:51], v[96:99]
    ds_read_b128 v[184:187], v14 offset:49152
    s_add_u32 s61, s59, 7
    v_mfma_f32_16x16x32_bf16 v[112:115], a[80:83], v[52:55], v[112:115]
    ds_read_b128 v[188:191], v15 offset:49152
    s_and_b32 s61, s61, 7
    v_mfma_f32_16x16x32_bf16 v[100:103], a[84:87], v[48:51], v[100:103]
    ds_read_b64_tr_b16 v[64:65], v16 offset:50176
    s_mul_i32 s61, s61, 196608
    v_mfma_f32_16x16x32_bf16 v[116:119], a[84:87], v[52:55], v[116:119]
    ds_read_b64_tr_b16 v[66:67], v16 offset:50688
    s_add_u32 s61, s61, s55
    v_mfma_f32_16x16x32_bf16 v[104:107], a[88:91], v[48:51], v[104:107]
    ds_read_b64_tr_b16 v[68:69], v16 offset:51200
    s_add_u32 s64, s61, s63
    v_mfma_f32_16x16x32_bf16 v[120:123], a[88:91], v[52:55], v[120:123]
    ds_read_b64_tr_b16 v[70:71], v16 offset:51712
    s_add_u32 m0, s62, 90112
    v_mfma_f32_16x16x32_bf16 v[108:111], a[92:95], v[48:51], v[108:111]
    buffer_load_dwordx4 v10, s[8:11], s64 offen offset:0 lds
    v_mfma_f32_16x16x32_bf16 v[124:127], a[92:95], v[52:55], v[124:127]
    ds_read_b64_tr_b16 a[152:153], v16 offset:49152
    v_mfma_f32_16x16x32_bf16 v[144:147], v[40:43], v[48:51], v[144:147]
    ds_read_b64_tr_b16 a[154:155], v16 offset:49664
    v_mfma_f32_16x16x32_bf16 v[148:151], v[40:43], v[52:55], v[148:151]
    buffer_load_dwordx4 v10, s[8:11], s61 offen offset:1024 lds
    v_mfma_f32_16x16x32_bf16 v[96:99], a[96:99], v[56:59], v[96:99]
    ds_read_b128 a[120:123], v12 offset:40960
    v_mfma_f32_16x16x32_bf16 v[112:115], a[96:99], v[60:63], v[112:115]
    ds_read_b128 a[124:127], v12 offset:43008
    v_mfma_f32_16x16x32_bf16 v[100:103], a[100:103], v[56:59], v[100:103]
    buffer_load_dwordx4 v10, s[8:11], s61 offen offset:2048 lds
    v_mfma_f32_16x16x32_bf16 v[116:119], a[100:103], v[60:63], v[116:119]
    ds_read_b128 a[128:131], v12 offset:45056
    s_add_u32 m0, s62, 93184
    v_mfma_f32_16x16x32_bf16 v[104:107], a[104:107], v[56:59], v[104:107]
    ds_read_b128 a[132:135], v12 offset:47104
    v_mfma_f32_16x16x32_bf16 v[120:123], a[104:107], v[60:63], v[120:123]
    buffer_load_dwordx4 v11, s[8:11], s64 offen offset:0 lds
    v_mfma_f32_16x16x32_bf16 v[108:111], a[108:111], v[56:59], v[108:111]
    ds_read_b64_tr_b16 v[72:73], v16 offset:53248
    v_mfma_f32_16x16x32_bf16 v[124:127], a[108:111], v[60:63], v[124:127]
    ds_read_b64_tr_b16 v[74:75], v16 offset:53760
    v_mfma_f32_16x16x32_bf16 v[144:147], v[40:43], v[56:59], v[144:147]
    buffer_load_dwordx4 v11, s[8:11], s61 offen offset:1024 lds
    v_mfma_f32_16x16x32_bf16 v[148:151], v[40:43], v[60:63], v[148:151]
    ds_read_b64_tr_b16 v[76:77], v16 offset:54272
    v_mfma_f32_16x16x32_bf16 v[128:131], a[112:115], a[80:83], v[128:131]
    ds_read_b64_tr_b16 v[78:79], v16 offset:54784
    v_mfma_f32_16x16x32_bf16 v[132:135], a[112:115], a[84:87], v[132:135]
    buffer_load_dwordx4 v11, s[8:11], s61 offen offset:2048 lds
    v_mfma_f32_16x16x32_bf16 v[136:139], a[112:115], a[88:91], v[136:139]
    ds_read_b64_tr_b16 a[156:157], v16 offset:52224
    v_mfma_f32_16x16x32_bf16 v[140:143], a[112:115], a[92:95], v[140:143]
    ds_read_b64_tr_b16 a[158:159], v16 offset:52736
    v_mfma_f32_16x16x32_bf16 v[152:155], a[112:115], v[40:43], v[152:155]
    s_cmp_ge_u32 s74, 176
    s_cbranch_scc1 L_nopd
    s_add_u32 m0, s57, 139264
    s_nop 0
    s_nop 0
    buffer_load_dwordx4 v178, s[28:31], s67 offen offset:0 lds
    s_nop 0
    buffer_load_dwordx4 v179, s[28:31], s67 offen offset:1024 lds
L_nopd:
    v_mfma_f32_16x16x32_bf16 v[128:131], a[116:119], a[96:99], v[128:131]
    ds_read_b128 a[136:139], v13 offset:40960
    s_add_u32 m0, s57, 147456
    v_mfma_f32_16x16x32_bf16 v[132:135], a[116:119], a[100:103], v[132:135]
    ds_read_b128 a[140:143], v13 offset:43008
    v_mfma_f32_16x16x32_bf16 v[136:139], a[116:119], a[104:107], v[136:139]
    buffer_load_dwordx4 v8, s[4:7], s68 offen offset:0 lds
    v_mfma_f32_16x16x32_bf16 v[140:143], a[116:119], a[108:111], v[140:143]
    ds_read_b128 a[144:147], v13 offset:45056
    v_mfma_f32_16x16x32_bf16 v[152:155], a[116:119], v[40:43], v[152:155]
    ds_read_b128 a[148:151], v13 offset:47104
    s_waitcnt lgkmcnt(15)
    v_mfma_f32_16x16x32_bf16 v[156:159], v[184:187], v[40:43], v[156:159]
    buffer_load_dwordx4 v9, s[4:7], s68 offen offset:1024 lds
    v_mfma_f32_16x16x32_bf16 v[160:163], v[184:187], v[184:187], v[160:163]
    v_mfma_f32_16x16x32_bf16 v[156:159], v[188:191], v[40:43], v[156:159]
    v_mfma_f32_16x16x32_bf16 v[160:163], v[188:191], v[188:191], v[160:163]
    s_mov_b32 s46, s2
    s_lshl_b32 s46, s46, 2
    s_add_u32 s44, s46, s47
    s_mul_i32 s46, s44, 1408
    buffer_load_dword v0, v176, s[24:27], s46 offen
    s_mul_i32 s46, s44, 512
    buffer_load_dword v0, v182, s[20:23], s46 offen
L_nohw:
    s_cmp_lg_u32 s47, 0
    s_cbranch_scc1 L_nob
    s_mul_i32 s46, s48, 384
    buffer_load_dword v0, v177, s[32:35], s46 offen
    s_lshl_b32 s46, s48, 7
    buffer_load_dword v0, v177, s[36:39], s46 offen
L_nob:
    s_waitcnt vmcnt(10)
    s_waitcnt vmcnt(8)
    s_waitcnt lgkmcnt(0)
    s_barrier
    v_mfma_f32_16x16x32_bf16 v[96:99], a[120:123], v[64:67], v[96:99]
    buffer_load_dword v20, v21, s[16:19], 0 offen sc1
    v_mfma_f32_16x16x32_bf16 v[112:115], a[120:123], v[68:71], v[112:115]
    ds_read_b128 v[184:187], v14 offset:57344
    s_lshl_b32 s67, s47, 17
    v_mfma_f32_16x16x32_bf16 v[100:103], a[124:127], v[64:67], v[100:103]
    ds_read_b128 v[188:191], v15 offset:57344
    s_lshl_b32 s44, s48, 7
    v_mfma_f32_16x16x32_bf16 v[116:119], a[124:127], v[68:71], v[116:119]
    ds_read_b64_tr_b16 v[48:49], v16 offset:1024
    s_add_u32 s67, s67, s44
    v_mfma_f32_16x16x32_bf16 v[104:107], a[128:131], v[64:67], v[104:107]
    ds_read_b64_tr_b16 v[50:51], v16 offset:1536
    s_lshl_b32 s68, s47, 14
    v_mfma_f32_16x16x32_bf16 v[120:123], a[128:131], v[68:71], v[120:123]
    ds_read_b64_tr_b16 v[52:53], v16 offset:2048
    s_mul_i32 s51, s48, 12
    v_mfma_f32_16x16x32_bf16 v[108:111], a[132:135], v[64:67], v[108:111]
    ds_read_b64_tr_b16 v[54:55], v16 offset:2560
    s_add_u32 s51, s51, s47
    v_mfma_f32_16x16x32_bf16 v[124:127], a[132:135], v[68:71], v[124:127]
    ds_read_b64_tr_b16 a[192:193], v16 offset:0
    s_mul_i32 s54, s47, 22016
    v_mfma_f32_16x16x32_bf16 v[144:147], v[40:43], v[64:67], v[144:147]
    ds_read_b64_tr_b16 a[194:195], v16 offset:512
    s_mul_i32 s44, s48, 384
    v_mfma_f32_16x16x32_bf16 v[148:151], v[40:43], v[68:71], v[148:151]
    ds_read_b128 a[160:163], v12 offset:49152
    s_add_u32 s54, s54, s44
    v_mfma_f32_16x16x32_bf16 v[96:99], a[136:139], v[72:75], v[96:99]
    ds_read_b128 a[164:167], v12 offset:51200
    v_mfma_f32_16x16x32_bf16 v[112:115], a[136:139], v[76:79], v[112:115]
    ds_read_b128 a[168:171], v12 offset:53248
    v_mfma_f32_16x16x32_bf16 v[100:103], a[140:143], v[72:75], v[100:103]
    ds_read_b128 a[172:175], v12 offset:55296
    v_mfma_f32_16x16x32_bf16 v[116:119], a[140:143], v[76:79], v[116:119]
    ds_read_b64_tr_b16 v[56:57], v16 offset:4096
    v_mfma_f32_16x16x32_bf16 v[104:107], a[144:147], v[72:75], v[104:107]
    ds_read_b64_tr_b16 v[58:59], v16 offset:4608
    v_mfma_f32_16x16x32_bf16 v[120:123], a[144:147], v[76:79], v[120:123]
    ds_read_b64_tr_b16 v[60:61], v16 offset:5120
    v_mfma_f32_16x16x32_bf16 v[108:111], a[148:151], v[72:75], v[108:111]
    ds_read_b64_tr_b16 v[62:63], v16 offset:5632
    v_mfma_f32_16x16x32_bf16 v[124:127], a[148:151], v[76:79], v[124:127]
    ds_read_b64_tr_b16 a[196:197], v16 offset:3072
    v_mfma_f32_16x16x32_bf16 v[144:147], v[40:43], v[72:75], v[144:147]
    ds_read_b64_tr_b16 a[198:199], v16 offset:3584
    v_mfma_f32_16x16x32_bf16 v[148:151], v[40:43], v[76:79], v[148:151]
    ds_read_b128 a[176:179], v13 offset:49152
    v_mfma_f32_16x16x32_bf16 v[128:131], a[152:155], a[120:123], v[128:131]
    ds_read_b128 a[180:183], v13 offset:51200
    v_mfma_f32_16x16x32_bf16 v[132:135], a[152:155], a[124:127], v[132:135]
    ds_read_b128 a[184:187], v13 offset:53248
    v_mfma_f32_16x16x32_bf16 v[136:139], a[152:155], a[128:131], v[136:139]
    ds_read_b128 a[188:191], v13 offset:55296
    v_mfma_f32_16x16x32_bf16 v[140:143], a[152:155], a[132:135], v[140:143]
    s_cmp_lt_u32 s48, 7
    s_cselect_b32 s10, 0, 2146435072
    v_mfma_f32_16x16x32_bf16 v[152:155], a[152:155], v[40:43], v[152:155]
    s_and_b32 s63, s49, 3
    s_lshl_b32 s63, s63, 1
    s_cmp_eq_u32 s48, 3
    s_cselect_b32 s63, s63, 0
    v_mfma_f32_16x16x32_bf16 v[128:131], a[156:159], a[136:139], v[128:131]
    s_add_u32 s61, s54, 0
    s_add_u32 s11, s61, s10
    s_add_u32 m0, s56, 114688
    v_mfma_f32_16x16x32_bf16 v[132:135], a[156:159], a[140:143], v[132:135]
    buffer_load_dwordx4 v3, s[24:27], s61 offen offset:0 lds
    v_mfma_f32_16x16x32_bf16 v[136:139], a[156:159], a[144:147], v[136:139]
L_hop1:
    s_cbranch_execz L_back0
    s_add_u32 m0, s56, 118656
    v_mfma_f32_16x16x32_bf16 v[140:143], a[156:159], a[148:151], v[140:143]
    v_mfma_f32_16x16x32_bf16 v[152:155], a[156:159], v[40:43], v[152:155]
    s_waitcnt lgkmcnt(15)
    v_mfma_f32_16x16x32_bf16 v[156:159], v[184:187], v[40:43], v[156:159]
    buffer_load_dwordx4 v3, s[24:27], s11 offen offset:128 lds
    v_mfma_f32_16x16x32_bf16 v[160:163], v[184:187], v[184:187], v[160:163]
    s_add_u32 m0, s56, 122624
    v_mfma_f32_16x16x32_bf16 v[156:159], v[188:191], v[40:43], v[156:159]
    v_mfma_f32_16x16x32_bf16 v[160:163], v[188:191], v[188:191], v[160:163]
    buffer_load_dwordx4 v3, s[24:27], s11 offen offset:256 lds
    s_waitcnt vmcnt(6)
    s_waitcnt lgkmcnt(0)
    s_barrier
    v_mfma_f32_16x16x32_bf16 v[96:99], a[160:163], v[48:51], v[96:99]
    ds_read_b64_tr_b16 v[64:65], v16 offset:25600
    s_nop 0
    v_cndmask_b32 v156, v156, v157, s[76:77]
    v_mfma_f32_16x16x32_bf16 v[112:115], a[160:163], v[52:55], v[112:115]
    ds_read_b64_tr_b16 v[66:67], v16 offset:26112
    v_cndmask_b32 v158, v158, v159, s[76:77]
    v_mfma_f32_16x16x32_bf16 v[100:103], a[164:167], v[48:51], v[100:103]
    ds_read_b64_tr_b16 v[68:69], v16 offset:26624
    v_cndmask_b32 v160, v160, v161, s[76:77]
    v_mfma_f32_16x16x32_bf16 v[116:119], a[164:167], v[52:55], v[116:119]
    ds_read_b64_tr_b16 v[70:71], v16 offset:27136
    v_cndmask_b32 v162, v162, v163, s[76:77]
    v_mfma_f32_16x16x32_bf16 v[104:107], a[168:171], v[48:51], v[104:107]
    ds_read_b64_tr_b16 a[232:233], v16 offset:24576
    v_cndmask_b32 v156, v156, v158, s[78:79]
    v_mfma_f32_16x16x32_bf16 v[120:123], a[168:171], v[52:55], v[120:123]
    ds_read_b64_tr_b16 a[234:235], v16 offset:25088
    v_cndmask_b32 v160, v160, v162, s[78:79]
    v_mfma_f32_16x16x32_bf16 v[108:111], a[172:175], v[48:51], v[108:111]
    ds_read_b128 a[200:203], v12 offset:57344
    v_mul_f32 v156, 0xbb000000, v156
    v_mfma_f32_16x16x32_bf16 v[124:127], a[172:175], v[52:55], v[124:127]
    ds_read_b128 a[204:207], v12 offset:59392
    v_mul_f32 v160, 0x3b000000, v160
    v_mfma_f32_16x16x32_bf16 v[144:147], v[40:43], v[48:51], v[144:147]
    ds_read_b128 a[208:211], v12 offset:61440
    v_fma_f32 v160, -v156, v156, v160
    v_mfma_f32_16x16x32_bf16 v[148:151], v[40:43], v[52:55], v[148:151]
    ds_read_b128 a[212:215], v12 offset:63488
    v_max_f32_e64 v160, 0, v160
    v_mfma_f32_16x16x32_bf16 v[96:99], a[176:179], v[56:59], v[96:99]
    ds_read_b64_tr_b16 v[72:73], v16 offset:28672
    v_add_f32 v160, s71, v160
    v_mfma_f32_16x16x32_bf16 v[112:115], a[176:179], v[60:63], v[112:115]
    ds_read_b64_tr_b16 v[74:75], v16 offset:29184
    s_add_u32 s61, s54, 88064
    v_mfma_f32_16x16x32_bf16 v[100:103], a[180:183], v[56:59], v[100:103]
    ds_read_b64_tr_b16 v[76:77], v16 offset:29696
    s_add_u32 s11, s61, s10
    v_mfma_f32_16x16x32_bf16 v[116:119], a[180:183], v[60:63], v[116:119]
    ds_read_b64_tr_b16 v[78:79], v16 offset:30208
    s_add_u32 m0, s56, 126976
    v_mfma_f32_16x16x32_bf16 v[104:107], a[184:187], v[56:59], v[104:107]
    ds_read_b64_tr_b16 a[236:237], v16 offset:27648
    v_mfma_f32_16x16x32_bf16 v[120:123], a[184:187], v[60:63], v[120:123]
    ds_read_b64_tr_b16 a[238:239], v16 offset:28160
    v_mfma_f32_16x16x32_bf16 v[108:111], a[188:191], v[56:59], v[108:111]
    ds_read_b128 a[216:219], v13 offset:57344
    v_mfma_f32_16x16x32_bf16 v[124:127], a[188:191], v[60:63], v[124:127]
    ds_read_b128 a[220:223], v13 offset:59392
    v_mfma_f32_16x16x32_bf16 v[144:147], v[40:43], v[56:59], v[144:147]
    ds_read_b128 a[224:227], v13 offset:61440
    v_mfma_f32_16x16x32_bf16 v[148:151], v[40:43], v[60:63], v[148:151]
    ds_read_b128 a[228:231], v13 offset:63488
    v_rsq_f32 v160, v160
    s_nop 0
    v_mul_f32 v157, 0x3fb8aa3b, v160
    s_mov_b32 exec_lo, 0x00f0000f
    s_mov_b32 exec_hi, 0xf0000f00
    ds_write_b32 v172, v156 offset:0
    ds_write_b32 v172, v160 offset:256
    ds_write_b32 v172, v157 offset:512
    ds_write_b64 v173, v[156:157] offset:768
    s_mov_b64 exec, -1
    buffer_load_dwordx4 v3, s[24:27], s61 offen offset:0 lds
    s_add_u32 m0, s56, 130944
    s_nop 0
    buffer_load_dwordx4 v3, s[24:27], s11 offen offset:128 lds
    s_add_u32 m0, s56, 134912
    s_nop 0
    buffer_load_dwordx4 v3, s[24:27], s11 offen offset:256 lds
    s_add_u32 s61, s54, 176128
    s_add_u32 s11, s61, s10
    s_add_u32 m0, s56, 65536
    s_nop 0
    buffer_load_dwordx4 v3, s[24:27], s61 offen offset:0 lds
    s_add_u32 m0, s56, 69504
    s_nop 0
    buffer_load_dwordx4 v3, s[24:27], s11 offen offset:128 lds
    s_add_u32 m0, s56, 73472
    s_nop 0
    buffer_load_dwordx4 v3, s[24:27], s11 offen offset:256 lds
    s_waitcnt vmcnt(10)
    s_waitcnt lgkmcnt(0)
    s_barrier
    v_mfma_f32_16x16x32_bf16 v[96:99], a[200:203], v[64:67], v[96:99]
    ds_read_b128 v[184:187], v174 offset:0
    s_add_u32 s61, s54, 264192
    v_mfma_f32_16x16x32_bf16 v[112:115], a[200:203], v[68:71], v[112:115]
    ds_read_b128 v[200:203], v174 offset:512
    s_add_u32 s11, s61, s10
    v_mfma_f32_16x16x32_bf16 v[100:103], a[204:207], v[64:67], v[100:103]
    ds_read_b128 v[188:191], v174 offset:64
    s_add_u32 m0, s56, 77824
    v_mfma_f32_16x16x32_bf16 v[116:119], a[204:207], v[68:71], v[116:119]
    ds_read_b128 v[204:207], v174 offset:576
    v_mfma_f32_16x16x32_bf16 v[104:107], a[208:211], v[64:67], v[104:107]
    ds_read_b128 v[192:195], v174 offset:128
    v_mfma_f32_16x16x32_bf16 v[120:123], a[208:211], v[68:71], v[120:123]
    ds_read_b128 v[208:211], v174 offset:640
    v_mfma_f32_16x16x32_bf16 v[108:111], a[212:215], v[64:67], v[108:111]
    ds_read_b128 v[196:199], v174 offset:192
    v_mfma_f32_16x16x32_bf16 v[124:127], a[212:215], v[68:71], v[124:127]
    ds_read_b128 v[212:215], v174 offset:704
    v_mfma_f32_16x16x32_bf16 v[144:147], v[40:43], v[64:67], v[144:147]
    ds_read_b128 v[216:219], v174 offset:256
    v_mfma_f32_16x16x32_bf16 v[148:151], v[40:43], v[68:71], v[148:151]
    ds_read_b64 v[232:233], v175 offset:768
    v_mfma_f32_16x16x32_bf16 v[96:99], a[216:219], v[72:75], v[96:99]
    ds_read_b128 v[220:223], v174 offset:320
    v_mfma_f32_16x16x32_bf16 v[112:115], a[216:219], v[76:79], v[112:115]
    ds_read_b64 v[234:235], v175 offset:896
    v_mfma_f32_16x16x32_bf16 v[100:103], a[220:223], v[72:75], v[100:103]
    ds_read_b128 v[224:227], v174 offset:384
    v_mfma_f32_16x16x32_bf16 v[116:119], a[220:223], v[76:79], v[116:119]
    ds_read_b64 v[236:237], v175 offset:1024
    v_mfma_f32_16x16x32_bf16 v[104:107], a[224:227], v[72:75], v[104:107]
    ds_read_b128 v[228:231], v174 offset:448
    v_mfma_f32_16x16x32_bf16 v[120:123], a[224:227], v[76:79], v[120:123]
    ds_read_b64 v[238:239], v175 offset:1152
    v_mfma_f32_16x16x32_bf16 v[108:111], a[228:231], v[72:75], v[108:111]
    ds_read_b64 v[24:25], v18 offset:0
    v_mfma_f32_16x16x32_bf16 v[124:127], a[228:231], v[76:79], v[124:127]
    ds_read_b64 v[26:27], v19 offset:0
    v_mfma_f32_16x16x32_bf16 v[144:147], v[40:43], v[72:75], v[144:147]
    ds_read_b64 v[28:29], v18 offset:4096
    v_mfma_f32_16x16x32_bf16 v[148:151], v[40:43], v[76:79], v[148:151]
    ds_read_b64 v[30:31], v19 offset:4096
    ds_read_b64_tr_b16 v[164:165], v32
    ds_read_b64_tr_b16 v[166:167], v32 offset:512
    ds_read_b64_tr_b16 v[168:169], v33
    ds_read_b64_tr_b16 v[170:171], v33 offset:512
    buffer_load_dwordx4 v3, s[24:27], s61 offen offset:0 lds
    s_add_u32 m0, s56, 81792
    s_nop 0
    buffer_load_dwordx4 v3, s[24:27], s11 offen offset:128 lds
    s_add_u32 m0, s56, 85760
    s_nop 0
    buffer_load_dwordx4 v3, s[24:27], s11 offen offset:256 lds
    s_add_u32 s64, s63, 0
    s_and_b32 s64, s64, 7
    s_lshl_b32 s60, s64, 14
    s_add_u32 s60, s60, s67
    s_lshl_b32 s64, s64, 11
    s_add_u32 m0, s64, s68
    s_nop 0
    buffer_load_dwordx4 v178, s[20:23], s60 offen offset:0 lds
    buffer_load_dwordx4 v179, s[20:23], s60 offen offset:1024 lds
    s_add_u32 s64, s63, 1
    s_and_b32 s64, s64, 7
    s_lshl_b32 s60, s64, 14
    s_add_u32 s60, s60, s67
    s_lshl_b32 s64, s64, 11
    s_add_u32 m0, s64, s68
    s_nop 0
    buffer_load_dwordx4 v178, s[20:23], s60 offen offset:0 lds
    s_mov_b32 s76, 0x35c1a2a0
    s_mov_b32 s77, 0x35c1a2a0
    s_mov_b32 s78, 0x3f317218
    s_mov_b32 s79, 0x3f317218
    s_waitcnt lgkmcnt(15)
    v_pk_fma_f32 v[96:97], v[184:185], v[144:145], v[96:97]
    v_pk_fma_f32 v[98:99], v[186:187], v[144:145], v[98:99]
    v_pk_fma_f32 v[100:101], v[188:189], v[144:145], v[100:101]
    v_pk_fma_f32 v[102:103], v[190:191], v[144:145], v[102:103]
    v_pk_fma_f32 v[104:105], v[192:193], v[144:145], v[104:105]
    v_pk_fma_f32 v[106:107], v[194:195], v[144:145], v[106:107]
    v_pk_fma_f32 v[108:109], v[196:197], v[144:145], v[108:109]
    v_pk_fma_f32 v[110:111], v[198:199], v[144:145], v[110:111]
    v_pk_fma_f32 v[96:97], v[96:97], v[200:201], s[76:77]
    v_pk_fma_f32 v[98:99], v[98:99], v[202:203], s[76:77]
    v_pk_fma_f32 v[100:101], v[100:101], v[204:205], s[76:77]
    v_pk_fma_f32 v[102:103], v[102:103], v[206:207], s[76:77]
    v_pk_fma_f32 v[104:105], v[104:105], v[208:209], s[76:77]
    v_pk_fma_f32 v[106:107], v[106:107], v[210:211], s[76:77]
    v_pk_fma_f32 v[108:109], v[108:109], v[212:213], s[76:77]
    v_pk_fma_f32 v[110:111], v[110:111], v[214:215], s[76:77]
    v_exp_f32 v240, v96 clamp
    v_exp_f32 v241, v97 clamp
    v_exp_f32 v242, v98 clamp
    v_exp_f32 v243, v99 clamp
    v_exp_f32 v244, v100 clamp
    v_exp_f32 v245, v101 clamp
    v_exp_f32 v246, v102 clamp
    v_exp_f32 v247, v103 clamp
    v_exp_f32 v248, v104 clamp
    v_exp_f32 v249, v105 clamp
    v_exp_f32 v250, v106 clamp
    v_exp_f32 v251, v107 clamp
    v_exp_f32 v252, v108 clamp
    v_exp_f32 v253, v109 clamp
    v_exp_f32 v254, v110 clamp
    v_exp_f32 v255, v111 clamp
    v_max_f32 v96, s76, v96
    v_max_f32 v97, s76, v97
    v_max_f32 v98, s76, v98
    v_max_f32 v99, s76, v99
    v_max_f32 v100, s76, v100
    v_max_f32 v101, s76, v101
    v_max_f32 v102, s76, v102
    v_max_f32 v103, s76, v103
    v_max_f32 v104, s76, v104
    v_max_f32 v105, s76, v105
    v_max_f32 v106, s76, v106
    v_max_f32 v107, s76, v107
    v_max_f32 v108, s76, v108
    v_max_f32 v109, s76, v109
    v_max_f32 v110, s76, v110
    v_max_f32 v111, s76, v111
    v_pk_fma_f32 v[96:97], v[96:97], s[78:79], v[240:241]
    v_pk_fma_f32 v[98:99], v[98:99], s[78:79], v[242:243]
    v_pk_fma_f32 v[100:101], v[100:101], s[78:79], v[244:245]
    v_pk_fma_f32 v[102:103], v[102:103], s[78:79], v[246:247]
    v_pk_fma_f32 v[104:105], v[104:105], s[78:79], v[248:249]
    v_pk_fma_f32 v[106:107], v[106:107], s[78:79], v[250:251]
    v_pk_fma_f32 v[108:109], v[108:109], s[78:79], v[252:253]
    v_pk_fma_f32 v[110:111], v[110:111], s[78:79], v[254:255]
    v_cvt_pk_bf16_f32 v48, v96, v97
    v_cvt_pk_bf16_f32 v49, v98, v99
    v_cvt_pk_bf16_f32 v50, v100, v101
    v_cvt_pk_bf16_f32 v51, v102, v103
    v_cvt_pk_bf16_f32 v52, v104, v105
    v_cvt_pk_bf16_f32 v53, v106, v107
    v_cvt_pk_bf16_f32 v54, v108, v109
    v_cvt_pk_bf16_f32 v55, v110, v111
    v_pk_fma_f32 v[112:113], v[184:185], v[148:149], v[112:113]
    v_pk_fma_f32 v[114:115], v[186:187], v[148:149], v[114:115]
    v_pk_fma_f32 v[116:117], v[188:189], v[148:149], v[116:117]
    v_pk_fma_f32 v[118:119], v[190:191], v[148:149], v[118:119]
    v_pk_fma_f32 v[120:121], v[192:193], v[148:149], v[120:121]
    v_pk_fma_f32 v[122:123], v[194:195], v[148:149], v[122:123]
    v_pk_fma_f32 v[124:125], v[196:197], v[148:149], v[124:125]
    v_pk_fma_f32 v[126:127], v[198:199], v[148:149], v[126:127]
    v_pk_mul_f32 v[112:113], v[112:113], v[216:217]
    v_pk_mul_f32 v[114:115], v[114:115], v[218:219]
    s_waitcnt lgkmcnt(13)
    v_pk_mul_f32 v[116:117], v[116:117], v[220:221]
    v_pk_mul_f32 v[118:119], v[118:119], v[222:223]
    s_waitcnt lgkmcnt(11)
    v_pk_mul_f32 v[120:121], v[120:121], v[224:225]
    v_pk_mul_f32 v[122:123], v[122:123], v[226:227]
    s_waitcnt lgkmcnt(9)
    v_pk_mul_f32 v[124:125], v[124:125], v[228:229]
    v_pk_mul_f32 v[126:127], v[126:127], v[230:231]
    v_cvt_pk_bf16_f32 v56, v112, v113
    v_cvt_pk_bf16_f32 v57, v114, v115
    v_cvt_pk_bf16_f32 v58, v116, v117
    v_cvt_pk_bf16_f32 v59, v118, v119
    v_cvt_pk_bf16_f32 v60, v120, v121
    v_cvt_pk_bf16_f32 v61, v122, v123
    v_cvt_pk_bf16_f32 v62, v124, v125
    v_cvt_pk_bf16_f32 v63, v126, v127
    v_mfma_f32_16x16x32_bf16 v[64:67], v[48:51], v[56:59], 0
    v_mfma_f32_16x16x32_bf16 v[68:71], v[48:51], v[40:43], 0
    v_mfma_f32_16x16x32_bf16 v[64:67], v[52:55], v[60:63], v[64:67]
    v_mfma_f32_16x16x32_bf16 v[68:71], v[52:55], v[40:43], v[68:71]
    s_waitcnt vmcnt(15)
    v_cmp_ne_u32 vcc, 0, v20
    s_nop 1
    s_cmp_eq_u32 vcc_lo, 255
    s_cbranch_scc1 L_ok1
    s_mov_b32 s45, 0
L_spin1:
    buffer_load_dword v20, v21, s[16:19], 0 offen sc1
    s_add_u32 s45, s45, 1
    s_waitcnt vmcnt(0)
    v_cmp_ne_u32 vcc, 0, v20
    s_cmp_ge_u32 s45, 262144
    s_cbranch_scc1 L_ok1
    s_nop 1
    s_nop 1
    s_cmp_eq_u32 vcc_lo, 255
    s_cbranch_scc0 L_spin1
L_ok1:
    s_nop 0
    ds_write_b128 v34, v[64:67]
    ds_write_b128 v35, v[68:71] offset:1024
    ds_read_b32 v72, v36 offset:0
    ds_read_b32 v73, v36 offset:256
    ds_read_b32 v74, v36 offset:512
    ds_read_b32 v75, v36 offset:768
    ds_read_b32 v76, v38 offset:1024
    v_mfma_f32_16x16x32_bf16 v[128:131], a[192:195], a[160:163], v[128:131]
    v_mfma_f32_16x16x32_bf16 v[132:135], a[192:195], a[164:167], v[132:135]
    v_mfma_f32_16x16x32_bf16 v[136:139], a[192:195], a[168:171], v[136:139]
    v_mfma_f32_16x16x32_bf16 v[140:143], a[192:195], a[172:175], v[140:143]
    s_waitcnt lgkmcnt(4)
    buffer_atomic_add_f32 v72, v37, s[12:15], s65 offen offset:0
    v_mfma_f32_16x16x32_bf16 v[152:155], a[192:195], v[40:43], v[152:155]
    v_mfma_f32_16x16x32_bf16 v[128:131], a[196:199], a[176:179], v[128:131]
    v_mfma_f32_16x16x32_bf16 v[132:135], a[196:199], a[180:183], v[132:135]
    v_mfma_f32_16x16x32_bf16 v[136:139], a[196:199], a[184:187], v[136:139]
    s_waitcnt lgkmcnt(3)
    buffer_atomic_add_f32 v73, v37, s[12:15], s65 offen offset:1024
    v_mfma_f32_16x16x32_bf16 v[140:143], a[196:199], a[188:191], v[140:143]
    v_mfma_f32_16x16x32_bf16 v[152:155], a[196:199], v[40:43], v[152:155]
    v_mfma_f32_16x16x32_bf16 v[128:131], a[232:235], a[200:203], v[128:131]
    v_mfma_f32_16x16x32_bf16 v[132:135], a[232:235], a[204:207], v[132:135]
    s_waitcnt lgkmcnt(2)
    buffer_atomic_add_f32 v74, v37, s[12:15], s65 offen offset:512
    v_mfma_f32_16x16x32_bf16 v[136:139], a[232:235], a[208:211], v[136:139]
    v_mfma_f32_16x16x32_bf16 v[140:143], a[232:235], a[212:215], v[140:143]
    v_mfma_f32_16x16x32_bf16 v[152:155], a[232:235], v[40:43], v[152:155]
    v_mfma_f32_16x16x32_bf16 v[128:131], a[236:239], a[216:219], v[128:131]
    s_waitcnt lgkmcnt(1)
    buffer_atomic_add_f32 v75, v37, s[12:15], s65 offen offset:1536
    v_mfma_f32_16x16x32_bf16 v[132:135], a[236:239], a[220:223], v[132:135]
    v_mfma_f32_16x16x32_bf16 v[136:139], a[236:239], a[224:227], v[136:139]
    v_mfma_f32_16x16x32_bf16 v[140:143], a[236:239], a[228:231], v[140:143]
    v_mfma_f32_16x16x32_bf16 v[152:155], a[236:239], v[40:43], v[152:155]
    s_waitcnt lgkmcnt(0)
    buffer_atomic_add_f32 v76, v39, s[12:15], s65 offen
    s_nop 5
    v_pk_fma_f32 v[128:129], v[232:233], v[152:153], v[128:129] op_sel_hi:[0,1,1]
    v_pk_fma_f32 v[130:131], v[232:233], v[154:155], v[130:131] op_sel_hi:[0,1,1]
    v_pk_fma_f32 v[132:133], v[234:235], v[152:153], v[132:133] op_sel_hi:[0,1,1]
    v_pk_fma_f32 v[134:135], v[234:235], v[154:155], v[134:135] op_sel_hi:[0,1,1]
    v_pk_fma_f32 v[136:137], v[236:237], v[152:153], v[136:137] op_sel_hi:[0,1,1]
    v_pk_fma_f32 v[138:139], v[236:237], v[154:155], v[138:139] op_sel_hi:[0,1,1]
    v_pk_fma_f32 v[140:141], v[238:239], v[152:153], v[140:141] op_sel_hi:[0,1,1]
    buffer_load_dwordx4 v179, s[20:23], s60 offen offset:1024 lds
    v_pk_fma_f32 v[142:143], v[238:239], v[154:155], v[142:143] op_sel_hi:[0,1,1]
    v_pk_fma_f32 v[128:129], v[128:129], v[232:233], s[76:77] op_sel:[0,1,0]
    v_pk_fma_f32 v[130:131], v[130:131], v[232:233], s[76:77] op_sel:[0,1,0]
    v_pk_fma_f32 v[132:133], v[132:133], v[234:235], s[76:77] op_sel:[0,1,0]
    v_pk_fma_f32 v[134:135], v[134:135], v[234:235], s[76:77] op_sel:[0,1,0]
    v_pk_fma_f32 v[136:137], v[136:137], v[236:237], s[76:77] op_sel:[0,1,0]
    v_pk_fma_f32 v[138:139], v[138:139], v[236:237], s[76:77] op_sel:[0,1,0]
    v_pk_fma_f32 v[140:141], v[140:141], v[238:239], s[76:77] op_sel:[0,1,0]
    v_pk_fma_f32 v[142:143], v[142:143], v[238:239], s[76:77] op_sel:[0,1,0]
    v_exp_f32 v240, v128 clamp
    v_exp_f32 v241, v129 clamp
    v_exp_f32 v242, v130 clamp
    v_exp_f32 v243, v131 clamp
    v_exp_f32 v244, v132 clamp
    s_add_u32 s64, s63, 2
    s_and_b32 s64, s64, 7
    s_lshl_b32 s60, s64, 14
    s_add_u32 s60, s60, s67
    s_lshl_b32 s64, s64, 11
    s_add_u32 m0, s64, s68
    s_nop 0
    buffer_load_dwordx4 v178, s[20:23], s60 offen offset:0 lds
    v_exp_f32 v245, v133 clamp
    v_exp_f32 v246, v134 clamp
    v_exp_f32 v247, v135 clamp
    v_exp_f32 v248, v136 clamp
    v_exp_f32 v249, v137 clamp
    v_exp_f32 v250, v138 clamp
    v_exp_f32 v251, v139 clamp
    v_exp_f32 v252, v140 clamp
    v_exp_f32 v253, v141 clamp
    v_exp_f32 v254, v142 clamp
    v_exp_f32 v255, v143 clamp
    v_max_f32 v128, s76, v128
    v_max_f32 v129, s76, v129
    v_max_f32 v130, s76, v130
    buffer_load_dwordx4 v179, s[20:23], s60 offen offset:1024 lds
    v_max_f32 v131, s76, v131
    v_max_f32 v132, s76, v132
    v_max_f32 v133, s76, v133
    v_max_f32 v134, s76, v134
    v_max_f32 v135, s76, v135
    v_max_f32 v136, s76, v136
    v_max_f32 v137, s76, v137
    v_max_f32 v138, s76, v138
    v_max_f32 v139, s76, v139
    v_max_f32 v140, s76, v140
    v_max_f32 v141, s76, v141
    v_max_f32 v142, s76, v142
    v_max_f32 v143, s76, v143
    v_pk_fma_f32 v[128:129], v[128:129], s[78:79], v[240:241]
    s_add_u32 s64, s63, 3
    s_and_b32 s64, s64, 7
    s_lshl_b32 s60, s64, 14
    s_add_u32 s60, s60, s67
    s_lshl_b32 s64, s64, 11
    s_add_u32 m0, s64, s68
    s_nop 0
    buffer_load_dwordx4 v178, s[20:23], s60 offen offset:0 lds
    v_pk_fma_f32 v[130:131], v[130:131], s[78:79], v[242:243]
    v_pk_fma_f32 v[132:133], v[132:133], s[78:79], v[244:245]
    v_pk_fma_f32 v[134:135], v[134:135], s[78:79], v[246:247]
    v_pk_fma_f32 v[136:137], v[136:137], s[78:79], v[248:249]
    v_pk_fma_f32 v[138:139], v[138:139], s[78:79], v[250:251]
    v_pk_fma_f32 v[140:141], v[140:141], s[78:79], v[252:253]
    v_pk_fma_f32 v[142:143], v[142:143], s[78:79], v[254:255]
    s_lshl_b32 s44, s52, 16
    s_xor_b32 s45, s53, 0
    s_lshl_b32 s45, s45, 10
    s_add_u32 s44, s44, s45
    s_add_u32 s44, s44, 0
    s_add_u32 s45, s44, 32768
    v_cvt_pk_bf16_f32 v80, v128, v129
    v_cvt_pk_bf16_f32 v81, v130, v131
    v_cvt_pk_bf16_f32 v82, v132, v133
    v_cvt_pk_bf16_f32 v83, v134, v135
    s_nop 0
    v_permlane16_swap_b32 v80, v82
    v_permlane16_swap_b32 v81, v83
    buffer_store_dwordx4 v[80:83], v2, s[12:15], s44 offen sc1
    v_cvt_pk_bf16_f32 v84, v136, v137
    v_cvt_pk_bf16_f32 v85, v138, v139
    v_cvt_pk_bf16_f32 v86, v140, v141
    v_cvt_pk_bf16_f32 v87, v142, v143
    s_nop 0
    v_permlane16_swap_b32 v84, v86
    v_permlane16_swap_b32 v85, v87
    s_waitcnt lgkmcnt(0)
    s_cmp_ge_u32 s74, 176
    s_cbranch_scc1 L_nops
    buffer_store_dwordx4 v[164:167], v2, s[12:15], s69 offen offset:0 sc1
    buffer_store_dwordx4 v[168:171], v2, s[12:15], s69 offen offset:1024 sc1
L_nops:
    buffer_store_dwordx4 v[84:87], v2, s[12:15], s45 offen sc1
    s_barrier
    buffer_load_dwordx4 v179, s[20:23], s60 offen offset:1024 lds
    s_add_u32 s64, s63, 4
    s_and_b32 s64, s64, 7
    s_lshl_b32 s60, s64, 14
    s_add_u32 s60, s60, s67
    s_lshl_b32 s64, s64, 11
    s_add_u32 m0, s64, s68
    s_nop 0
    buffer_load_dwordx4 v178, s[20:23], s60 offen offset:0 lds
    buffer_load_dwordx4 v179, s[20:23], s60 offen offset:1024 lds
    s_add_u32 s64, s63, 5
    s_and_b32 s64, s64, 7
    s_lshl_b32 s60, s64, 14
    s_add_u32 s60, s60, s67
    s_lshl_b32 s64, s64, 11
    s_add_u32 m0, s64, s68
    s_nop 0
    buffer_load_dwordx4 v178, s[20:23], s60 offen offset:0 lds
    v_bfe_u32 v4, v1, 4, 1
    v_bfe_u32 v5, v1, 3, 1
    v_lshl_or_b32 v5, v5, 1, v4
    v_xor_b32 v5, s47, v5
    v_lshlrev_b32 v5, 5, v5
    v_and_b32_e64 v6, 3, v1
    v_lshl_add_u32 v5, v6, 3, v5
    v_bfe_u32 v6, v1, 2, 2
    v_lshl_add_u32 v5, v6, 7, v5
    v_lshrrev_b32_e64 v7, 5, v1
    v_lshl_add_u32 v5, v7, 9, v5
    v_add_u32 v12, s68, v5
    v_xor_b32 v13, 64, v12
    v_lshl_add_u32 v5, v4, 11, v5
    v_add_u32 v8, 65536, v5
    v_add_u32 v9, 114688, v5
    v_mov_b32 v22, 1
    v_lshlrev_b32 v23, 24, v1
    v_lshlrev_b32 v5, 8, v1
    v_lshl_add_u32 v14, v7, 30, v5
    v_lshlrev_b32 v20, 14, v4
    v_lshl_add_u32 v20, v7, 9, v20
    v_and_b32_e64 v5, 15, v1
    v_lshl_add_u32 v20, v5, 4, v20
    v_and_b32 v5, 31, v1
    v_lshlrev_b32 v5, 3, v5
    v_lshl_add_u32 v21, v7, 13, v5
    v_lshrrev_b32 v4, 3, v1
    v_lshlrev_b32 v4, 26, v4
    v_lshl_add_u32 v10, v1, 7, v4
    v_and_b32_e64 v4, 31, v1
    v_min_u32 v4, 16, v4
    v_lshlrev_b32 v4, 4, v4
    v_lshl_add_u32 v11, v7, 9, v4
    buffer_load_dwordx4 v179, s[20:23], s60 offen offset:1024 lds
    s_add_u32 s64, s63, 6
    s_and_b32 s64, s64, 7
    s_lshl_b32 s60, s64, 14
    s_add_u32 s60, s60, s67
    s_lshl_b32 s64, s64, 11
    s_add_u32 m0, s64, s68
    s_nop 0
    buffer_load_dwordx4 v178, s[20:23], s60 offen offset:0 lds
    buffer_load_dwordx4 v179, s[20:23], s60 offen offset:1024 lds
    s_add_u32 s64, s63, 7
    s_and_b32 s64, s64, 7
    s_lshl_b32 s60, s64, 14
    s_add_u32 s60, s60, s67
    s_lshl_b32 s64, s64, 11
    s_add_u32 m0, s64, s68
    s_nop 0
    buffer_load_dwordx4 v178, s[20:23], s60 offen offset:0 lds
    s_xor_b32 s44, s47, 1
    s_lshl_b32 s44, s44, 13
    s_add_u32 s44, s44, 2048
    v_add_u32 v16, s44, v2
    s_xor_b32 s44, s47, 2
    s_lshl_b32 s44, s44, 13
    s_add_u32 s44, s44, 4096
    v_add_u32 v17, s44, v2
    s_xor_b32 s44, s47, 3
    s_lshl_b32 s44, s44, 13
    s_add_u32 s44, s44, 6144
    v_add_u32 v18, s44, v2
    s_lshl_b32 s44, s47, 13
    v_add_u32 v19, s44, v2
    s_add_u32 s8, s68, 3538944
    s_lshl_b32 s9, s49, 16
    s_add_u32 s9, s9, s44
    s_add_u32 s9, s9, 0
    s_lshl_b32 s4, s49, 16
    s_lshr_b32 s44, s50, 1
    s_lshl_b32 s44, s44, 10
    s_add_u32 s4, s4, s44
    s_and_b32 s44, s47, 1
    s_lshl_b32 s44, s44, 8
    s_add_u32 s4, s4, s44
    s_add_u32 s4, s4, 3637248
    s_lshl_b32 s5, s49, 14
    s_lshl_b32 s44, s50, 8
    s_add_u32 s5, s5, s44
    s_add_u32 s5, s5, 5734400
    s_mov_b32 s69, 0x358637bd
    s_and_b32 s44, s52, 3
    s_lshl_b32 s45, s53, 2
    s_add_u32 s44, s44, s45
    s_lshl_b32 s44, s44, 8
    s_add_u32 s44, s44, 3604480
    s_lshl_b32 s62, s47, 13
    s_add_u32 s62, s62, 3604480
    s_waitcnt vmcnt(8)
    buffer_atomic_add v22, v23, s[12:15], s44 offen
    buffer_load_dwordx4 v179, s[20:23], s60 offen offset:1024 lds
    s_add_u32 s61, s54, 352256
    s_add_u32 s11, s61, s10
    s_add_u32 m0, s56, 90112
    s_nop 0
    buffer_load_dwordx4 v3, s[24:27], s61 offen offset:0 lds
    s_add_u32 m0, s56, 94080
    s_nop 0
    buffer_load_dwordx4 v3, s[24:27], s11 offen offset:128 lds
    s_add_u32 m0, s56, 98048
    s_nop 0
    buffer_load_dwordx4 v3, s[24:27], s11 offen offset:256 lds
    s_add_u32 s61, s54, 440320
    s_add_u32 s11, s61, s10
    s_add_u32 m0, s56, 102400
    s_nop 0
    buffer_load_dwordx4 v3, s[24:27], s61 offen offset:0 lds
    s_add_u32 m0, s56, 106368
    s_nop 0
    buffer_load_dwordx4 v3, s[24:27], s11 offen offset:128 lds
    s_add_u32 m0, s56, 110336
    s_nop 0
    buffer_load_dwordx4 v3, s[24:27], s11 offen offset:256 lds
    s_add_u32 s61, s54, 528384
    s_add_u32 s11, s61, s10
    s_add_u32 m0, s56, 139264
    s_nop 0
    buffer_load_dwordx4 v3, s[24:27], s61 offen offset:0 lds
    s_add_u32 m0, s56, 143232
    s_nop 0
    buffer_load_dwordx4 v3, s[24:27], s11 offen offset:128 lds
    s_add_u32 m0, s56, 147200
    s_nop 0
    buffer_load_dwordx4 v3, s[24:27], s11 offen offset:256 lds
    s_add_u32 s61, s54, 616448
    s_add_u32 s11, s61, s10
    s_add_u32 m0, s56, 151552
    s_nop 0
    buffer_load_dwordx4 v3, s[24:27], s61 offen offset:0 lds
    s_add_u32 m0, s56, 155520
    s_nop 0
    buffer_load_dwordx4 v3, s[24:27], s11 offen offset:128 lds
    s_add_u32 m0, s56, 159488
    s_nop 0
    buffer_load_dwordx4 v3, s[24:27], s11 offen offset:256 lds
    s_mul_i32 s44, s49, 180224
    s_mul_i32 s45, s47, 22528
    s_add_u32 s44, s44, s45
    s_add_u32 s6, s44, 6258688
    s_mul_i32 s45, s48, 3072
    s_add_u32 s65, s6, s45
    s_add_u32 s53, s65, s10
    s_mov_b32 s76, 0xbdd2d3e8
    s_mov_b32 s77, 0xbdd2d3e8
    s_mul_i32 s67, s50, 45056
    s_add_u32 s67, s67, 2097152
    s_mov_b64 exec, 0
    s_cmp_eq_u32 s47, 0
    s_cbranch_scc1 L_hop3
    s_cmp_eq_u32 s47, 1
    s_cbranch_scc1 L_hop4
    s_cmp_eq_u32 s47, 2
    s_cbranch_scc1 L_hop5
L_back1:
    s_mov_b64 exec, -1
    s_waitcnt vmcnt(12)
    ds_read_b64_tr_b16 v[48:49], v12 offset:0
    ds_read_b64_tr_b16 v[50:51], v12 offset:1024
    ds_read_b64_tr_b16 v[52:53], v13 offset:0
    ds_read_b64_tr_b16 v[54:55], v13 offset:1024
    ds_read_b64_tr_b16 v[56:57], v12 offset:2048
    ds_read_b64_tr_b16 v[58:59], v12 offset:3072
    ds_read_b64_tr_b16 v[60:61], v13 offset:2048
    ds_read_b64_tr_b16 v[62:63], v13 offset:3072
    ds_read_b64_tr_b16 v[64:65], v12 offset:4096
    ds_read_b64_tr_b16 v[66:67], v12 offset:5120
    ds_read_b64_tr_b16 v[68:69], v13 offset:4096
    ds_read_b64_tr_b16 v[70:71], v13 offset:5120
    ds_read_b64_tr_b16 v[72:73], v12 offset:6144
    ds_read_b64_tr_b16 v[74:75], v12 offset:7168
    ds_read_b64_tr_b16 v[76:77], v13 offset:6144
    ds_read_b64_tr_b16 v[78:79], v13 offset:7168
    ds_read_b64_tr_b16 v[80:81], v12 offset:8192
    ds_read_b64_tr_b16 v[82:83], v12 offset:9216
L_hop2:
    s_cbranch_execz L_back0
    ds_read_b64_tr_b16 v[84:85], v13 offset:8192
    ds_read_b64_tr_b16 v[86:87], v13 offset:9216
    ds_read_b64_tr_b16 v[88:89], v12 offset:10240
    ds_read_b64_tr_b16 v[90:91], v12 offset:11264
    ds_read_b64_tr_b16 v[92:93], v13 offset:10240
    ds_read_b64_tr_b16 v[94:95], v13 offset:11264
    ds_read_b64_tr_b16 v[96:97], v12 offset:12288
    ds_read_b64_tr_b16 v[98:99], v12 offset:13312
    ds_read_b64_tr_b16 v[100:101], v13 offset:12288
    ds_read_b64_tr_b16 v[102:103], v13 offset:13312
    ds_read_b64_tr_b16 v[104:105], v12 offset:14336
    ds_read_b64_tr_b16 v[106:107], v12 offset:15360
    ds_read_b64_tr_b16 v[108:109], v13 offset:14336
    ds_read_b64_tr_b16 v[110:111], v13 offset:15360
    s_barrier
    ds_read_b64_tr_b16 a[0:1], v9 offset:0
    ds_read_b64_tr_b16 a[2:3], v9 offset:1024
    ds_read_b64_tr_b16 a[4:5], v9 offset:4096
    ds_read_b64_tr_b16 a[6:7], v9 offset:5120
    ds_read_b64_tr_b16 a[8:9], v9 offset:8192
    ds_read_b64_tr_b16 a[10:11], v9 offset:9216
    ds_read_b64_tr_b16 a[12:13], v9 offset:12288
    ds_read_b64_tr_b16 a[14:15], v9 offset:13312
    ds_read_b64_tr_b16 a[16:17], v9 offset:16384
    ds_read_b64_tr_b16 a[18:19], v9 offset:17408
    ds_read_b64_tr_b16 a[20:21], v9 offset:20480
    ds_read_b64_tr_b16 a[22:23], v9 offset:21504
    s_waitcnt lgkmcnt(0)
    s_barrier
    s_add_u32 s61, s54, 704512
    s_add_u32 s11, s61, s10
    s_add_u32 m0, s56, 114688
    s_nop 0
    buffer_load_dwordx4 v3, s[24:27], s61 offen offset:0 lds
    ds_read_b64_tr_b16 a[24:25], v8 offset:0
    ds_read_b64_tr_b16 a[26:27], v8 offset:1024
    v_mfma_f32_16x16x32_bf16 v[44:47], a[0:3], v[40:43], 0
    s_add_u32 m0, s56, 118656
    s_nop 0
    buffer_load_dwordx4 v3, s[24:27], s11 offen offset:128 lds
    ds_read_b64_tr_b16 a[28:29], v8 offset:4096
    ds_read_b64_tr_b16 a[30:31], v8 offset:5120
    v_mfma_f32_16x16x32_bf16 v[152:155], a[4:7], v[40:43], 0
    s_add_u32 m0, s56, 122624
    s_nop 0
    buffer_load_dwordx4 v3, s[24:27], s11 offen offset:256 lds
    ds_read_b64_tr_b16 a[32:33], v8 offset:8192
    ds_read_b64_tr_b16 a[34:35], v8 offset:9216
    v_mfma_f32_16x16x32_bf16 v[156:159], a[8:11], v[40:43], 0
    s_add_u32 s61, s54, 792576
    s_add_u32 s11, s61, s10
    s_add_u32 m0, s56, 126976
    s_nop 0
    buffer_load_dwordx4 v3, s[24:27], s61 offen offset:0 lds
    ds_read_b64_tr_b16 a[36:37], v8 offset:12288
    ds_read_b64_tr_b16 a[38:39], v8 offset:13312
    v_mfma_f32_16x16x32_bf16 v[44:47], a[12:15], v[40:43], v[44:47]
    s_add_u32 m0, s56, 130944
    s_nop 0
    buffer_load_dwordx4 v3, s[24:27], s11 offen offset:128 lds
    ds_read_b64_tr_b16 a[40:41], v8 offset:16384
    ds_read_b64_tr_b16 a[42:43], v8 offset:17408
    v_mfma_f32_16x16x32_bf16 v[152:155], a[16:19], v[40:43], v[152:155]
    s_add_u32 m0, s56, 134912
    s_nop 0
    buffer_load_dwordx4 v3, s[24:27], s11 offen offset:256 lds
    ds_read_b64_tr_b16 a[44:45], v8 offset:20480
    ds_read_b64_tr_b16 a[46:47], v8 offset:21504
    v_mfma_f32_16x16x32_bf16 v[156:159], a[20:23], v[40:43], v[156:159]
    s_waitcnt vmcnt(12)
    s_waitcnt lgkmcnt(0)
    s_barrier
    s_add_u32 s61, s54, 880640
    s_add_u32 s11, s61, s10
    s_add_u32 m0, s56, 65536
    s_nop 0
    buffer_load_dwordx4 v3, s[24:27], s61 offen offset:0 lds
    ds_read_b64_tr_b16 a[48:49], v8 offset:24576
    ds_read_b64_tr_b16 a[50:51], v8 offset:25600
    v_mfma_f32_16x16x32_bf16 v[44:47], a[24:27], v[40:43], v[44:47]
    s_add_u32 m0, s56, 69504
    s_nop 0
    buffer_load_dwordx4 v3, s[24:27], s11 offen offset:128 lds
    ds_read_b64_tr_b16 a[52:53], v8 offset:28672
    ds_read_b64_tr_b16 a[54:55], v8 offset:29696
    v_mfma_f32_16x16x32_bf16 v[152:155], a[28:31], v[40:43], v[152:155]
    s_add_u32 m0, s56, 73472
    s_nop 0
    buffer_load_dwordx4 v3, s[24:27], s11 offen offset:256 lds
    ds_read_b64_tr_b16 a[56:57], v8 offset:32768
    ds_read_b64_tr_b16 a[58:59], v8 offset:33792
    v_mfma_f32_16x16x32_bf16 v[156:159], a[32:35], v[40:43], v[156:159]
    s_add_u32 s61, s54, 968704
    s_add_u32 s11, s61, s10
    s_add_u32 m0, s56, 77824
    s_nop 0
    buffer_load_dwordx4 v3, s[24:27], s61 offen offset:0 lds
    ds_read_b64_tr_b16 a[60:61], v8 offset:36864
    ds_read_b64_tr_b16 a[62:63], v8 offset:37888
    v_mfma_f32_16x16x32_bf16 v[44:47], a[36:39], v[40:43], v[44:47]
    s_add_u32 m0, s56, 81792
    s_nop 0
    buffer_load_dwordx4 v3, s[24:27], s11 offen offset:128 lds
    ds_read_b64_tr_b16 a[64:65], v8 offset:40960
    ds_read_b64_tr_b16 a[66:67], v8 offset:41984
    v_mfma_f32_16x16x32_bf16 v[152:155], a[40:43], v[40:43], v[152:155]
    s_add_u32 m0, s56, 85760
    s_nop 0
    buffer_load_dwordx4 v3, s[24:27], s11 offen offset:256 lds
    ds_read_b64_tr_b16 a[68:69], v8 offset:45056
    ds_read_b64_tr_b16 a[70:71], v8 offset:46080
    v_mfma_f32_16x16x32_bf16 v[156:159], a[44:47], v[40:43], v[156:159]
    s_waitcnt vmcnt(12)
    s_barrier
    ds_read_b64_tr_b16 a[72:73], v9 offset:24576
    ds_read_b64_tr_b16 a[74:75], v9 offset:25600
    ds_read_b64_tr_b16 a[76:77], v9 offset:28672
    ds_read_b64_tr_b16 a[78:79], v9 offset:29696
    ds_read_b64_tr_b16 a[80:81], v9 offset:32768
    ds_read_b64_tr_b16 a[82:83], v9 offset:33792
    ds_read_b64_tr_b16 a[84:85], v9 offset:36864
    ds_read_b64_tr_b16 a[86:87], v9 offset:37888
    ds_read_b64_tr_b16 a[88:89], v9 offset:40960
    ds_read_b64_tr_b16 a[90:91], v9 offset:41984
    ds_read_b64_tr_b16 a[92:93], v9 offset:45056
    ds_read_b64_tr_b16 a[94:95], v9 offset:46080
    buffer_load_dword v15, v14, s[12:15], s62 offen sc1
    s_waitcnt lgkmcnt(15)
    v_mfma_f32_16x16x32_bf16 v[44:47], a[48:51], v[40:43], v[44:47]
    v_mfma_f32_16x16x32_bf16 v[152:155], a[52:55], v[40:43], v[152:155]
    v_mfma_f32_16x16x32_bf16 v[156:159], a[56:59], v[40:43], v[156:159]
    v_mfma_f32_16x16x32_bf16 v[44:47], a[60:63], v[40:43], v[44:47]
    s_waitcnt lgkmcnt(14)
    v_mfma_f32_16x16x32_bf16 v[152:155], a[64:67], v[40:43], v[152:155]
    s_waitcnt lgkmcnt(12)
    v_mfma_f32_16x16x32_bf16 v[156:159], a[68:71], v[40:43], v[156:159]
    s_waitcnt lgkmcnt(10)
    v_mfma_f32_16x16x32_bf16 v[44:47], a[72:75], v[40:43], v[44:47]
    s_waitcnt lgkmcnt(8)
    v_mfma_f32_16x16x32_bf16 v[152:155], a[76:79], v[40:43], v[152:155]
    s_waitcnt lgkmcnt(6)
    v_mfma_f32_16x16x32_bf16 v[156:159], a[80:83], v[40:43], v[156:159]
    s_waitcnt lgkmcnt(4)
    v_mfma_f32_16x16x32_bf16 v[44:47], a[84:87], v[40:43], v[44:47]
    s_waitcnt lgkmcnt(2)
    v_mfma_f32_16x16x32_bf16 v[152:155], a[88:91], v[40:43], v[152:155]
    s_waitcnt lgkmcnt(0)
    v_mfma_f32_16x16x32_bf16 v[156:159], a[92:95], v[40:43], v[156:159]
    s_waitcnt vmcnt(0)
    v_cmp_eq_u32 vcc, 8, v15
    s_nop 1
    s_cmp_eq_u32 vcc_lo, -1
    s_cbranch_scc1 L_ok2
    s_mov_b32 s45, 0
L_spin2:
    buffer_load_dword v15, v14, s[12:15], s62 offen sc1
    s_add_u32 s45, s45, 1
    s_waitcnt vmcnt(0)
    v_cmp_eq_u32 vcc, 8, v15
    s_cmp_ge_u32 s45, 262144
    s_cbranch_scc1 L_ok2
    s_nop 1
    s_nop 1
    s_cmp_eq_u32 vcc_lo, -1
    s_cbranch_scc0 L_spin2
L_ok2:
    buffer_load_dwordx4 v[224:227], v11, s[12:15], s8 offen offset:0 sc1
    buffer_load_dwordx4 v[228:231], v11, s[12:15], s8 offen offset:1024 sc1
    buffer_load_dwordx4 a[192:195], v2, s[12:15], s9 offen offset:0 sc1
    buffer_load_dwordx4 v[232:235], v11, s[12:15], s8 offen offset:2048 sc1
    buffer_load_dwordx4 v[236:239], v11, s[12:15], s8 offen offset:3072 sc1
    buffer_load_dwordx4 a[196:199], v2, s[12:15], s9 offen offset:1024 sc1
    s_add_u32 s46, s8, 4096
    buffer_load_dwordx4 v[240:243], v11, s[12:15], s46 offen offset:0 sc1
    s_add_u32 s46, s8, 4096
    buffer_load_dwordx4 v[244:247], v11, s[12:15], s46 offen offset:1024 sc1
    buffer_load_dwordx4 a[200:203], v2, s[12:15], s9 offen offset:2048 sc1
    s_add_u32 s46, s8, 4096
    buffer_load_dwordx4 v[248:251], v11, s[12:15], s46 offen offset:2048 sc1
    s_add_u32 s46, s8, 4096
    buffer_load_dwordx4 v[252:255], v11, s[12:15], s46 offen offset:3072 sc1
    buffer_load_dwordx4 a[204:207], v2, s[12:15], s9 offen offset:3072 sc1
    s_waitcnt lgkmcnt(0)
    s_barrier
    v_lshrrev_b32 v6, 5, v1
    v_lshlrev_b32 v6, 30, v6
    v_lshl_add_u32 v6, v1, 7, v6
    buffer_load_dword v7, v6, s[12:15], s66 offen offset:16 sc1
    s_lshl_b32 s80, s48, 7
    s_add_u32 s80, s80, s66
    s_and_b32 s44, s47, 1
    s_lshl_b32 s44, s44, 8
    s_lshr_b32 s45, s47, 1
    s_lshl_b32 s45, s45, 10
    s_add_u32 s44, s44, s45
    v_xor_b32 v14, s44, v2
    v_xor_b32 v15, 1024, v14
    s_waitcnt vmcnt(12)
    v_cvt_pk_bf16_f32 v112, v224, v225
    v_cvt_pk_bf16_f32 v113, v226, v227
    s_waitcnt vmcnt(11)
    v_cvt_pk_bf16_f32 v114, v228, v229
    v_cvt_pk_bf16_f32 v115, v230, v231
    s_waitcnt vmcnt(10)
    s_nop 0
    v_mfma_f32_32x32x16_bf16 v[192:207], v[112:115], a[192:195], 0
    s_waitcnt vmcnt(9)
    v_cvt_pk_bf16_f32 v116, v232, v233
    v_cvt_pk_bf16_f32 v117, v234, v235
    s_waitcnt vmcnt(8)
    v_cvt_pk_bf16_f32 v118, v236, v237
    v_cvt_pk_bf16_f32 v119, v238, v239
    s_waitcnt vmcnt(7)
    s_nop 0
    v_mfma_f32_32x32x16_bf16 v[208:223], v[116:119], a[196:199], 0
    s_add_u32 s46, s8, 8192
    buffer_load_dwordx4 v[224:227], v11, s[12:15], s46 offen offset:0 sc1
    s_add_u32 s46, s8, 8192
    v_add_f32_e64 v200, s69, v200
    v_rcp_f32 v200, v200
    s_waitcnt vmcnt(7)
    v_cvt_pk_bf16_f32 v120, v240, v241
    v_cvt_pk_bf16_f32 v121, v242, v243
    buffer_load_dwordx4 v[228:231], v11, s[12:15], s46 offen offset:1024 sc1
    s_add_u32 s46, s9, 4096
    buffer_load_dwordx4 a[208:211], v2, s[12:15], s46 offen offset:0 sc1
    v_mul_f32 v192, v192, v200
    v_mul_f32 v193, v193, v200
    v_mul_f32 v194, v194, v200
    v_mul_f32 v195, v195, v200
    v_mul_f32 v196, v196, v200
    ds_read_b64_tr_b16 a[96:97], v9 offset:0
    ds_read_b64_tr_b16 a[98:99], v9 offset:1024
    ds_read_b64_tr_b16 a[100:101], v9 offset:4096
    v_mul_f32 v197, v197, v200
    v_mul_f32 v198, v198, v200
    v_mul_f32 v199, v199, v200
    v_cvt_pk_bf16_f32 v144, v192, v193
    v_cvt_pk_bf16_f32 v145, v194, v195
    v_cvt_pk_bf16_f32 v146, v196, v197
    v_cvt_pk_bf16_f32 v147, v198, v199
    s_waitcnt vmcnt(8)
    v_cvt_pk_bf16_f32 v122, v244, v245
    v_cvt_pk_bf16_f32 v123, v246, v247
    s_waitcnt vmcnt(7)
    s_nop 0
    v_mfma_f32_32x32x16_bf16 v[192:207], v[120:123], a[200:203], 0
    s_add_u32 s46, s8, 8192
    buffer_load_dwordx4 v[232:235], v11, s[12:15], s46 offen offset:2048 sc1
    s_add_u32 s46, s8, 8192
    v_add_f32 v216, s69, v216
    v_rcp_f32 v216, v216
    s_waitcnt vmcnt(7)
    v_cvt_pk_bf16_f32 v124, v248, v249
    v_cvt_pk_bf16_f32 v125, v250, v251
    v_mfma_f32_32x32x16_bf16 v[160:175], v[48:51], v[144:147], 0
    buffer_load_dwordx4 v[236:239], v11, s[12:15], s46 offen offset:3072 sc1
    s_add_u32 s46, s9, 4096
    buffer_load_dwordx4 a[212:215], v2, s[12:15], s46 offen offset:1024 sc1
    v_mul_f32_e64 v208, v208, v216
    v_mul_f32 v209, v209, v216
    v_mul_f32 v210, v210, v216
    v_mul_f32 v211, v211, v216
    v_mul_f32 v212, v212, v216
    v_mfma_f32_32x32x16_bf16 v[176:191], v[52:55], v[144:147], 0
    ds_read_b64_tr_b16 a[102:103], v9 offset:5120
    ds_read_b64_tr_b16 a[104:105], v9 offset:8192
    ds_read_b64_tr_b16 a[106:107], v9 offset:9216
    v_mul_f32 v213, v213, v216
    v_mul_f32 v214, v214, v216
    v_mul_f32_e64 v215, v215, v216
    v_cvt_pk_bf16_f32 v148, v208, v209
    v_cvt_pk_bf16_f32 v149, v210, v211
    v_cvt_pk_bf16_f32 v150, v212, v213
    v_cvt_pk_bf16_f32 v151, v214, v215
    s_waitcnt vmcnt(8)
    v_cvt_pk_bf16_f32 v126, v252, v253
    v_cvt_pk_bf16_f32 v127, v254, v255
    s_waitcnt vmcnt(7)
    s_nop 0
    v_mfma_f32_32x32x16_bf16 v[208:223], v[124:127], a[204:207], 0
    s_add_u32 s46, s8, 12288
    buffer_load_dwordx4 v[240:243], v11, s[12:15], s46 offen offset:0 sc1
    s_add_u32 s46, s8, 12288
    v_add_f32 v200, s69, v200
    v_rcp_f32 v200, v200
    s_waitcnt vmcnt(6)
    v_cvt_pk_bf16_f32 v128, v224, v225
    v_cvt_pk_bf16_f32 v129, v226, v227
    v_mfma_f32_32x32x16_bf16 v[160:175], v[56:59], v[148:151], v[160:175]
    buffer_load_dwordx4 v[244:247], v11, s[12:15], s46 offen offset:1024 sc1
    s_add_u32 s46, s9, 4096
    buffer_load_dwordx4 a[216:219], v2, s[12:15], s46 offen offset:2048 sc1
    v_mul_f32_e64 v192, v192, v200
    v_mul_f32 v193, v193, v200
    v_mul_f32 v194, v194, v200
    v_mul_f32 v195, v195, v200
    v_mul_f32 v196, v196, v200
    v_mfma_f32_32x32x16_bf16 v[176:191], v[60:63], v[148:151], v[176:191]
    ds_read_b64_tr_b16 a[108:109], v9 offset:12288
    ds_read_b64_tr_b16 a[110:111], v9 offset:13312
    ds_read_b64_tr_b16 a[112:113], v9 offset:16384
    v_mul_f32 v197, v197, v200
    v_mul_f32 v198, v198, v200
    v_mul_f32_e64 v199, v199, v200
    v_cvt_pk_bf16_f32 v144, v192, v193
    v_cvt_pk_bf16_f32 v145, v194, v195
    v_cvt_pk_bf16_f32 v146, v196, v197
    v_cvt_pk_bf16_f32 v147, v198, v199
    s_waitcnt vmcnt(7)
    v_cvt_pk_bf16_f32 v130, v228, v229
    v_cvt_pk_bf16_f32 v131, v230, v231
    s_waitcnt vmcnt(6)
    s_nop 0
    v_mfma_f32_32x32x16_bf16 v[192:207], v[128:131], a[208:211], 0
    s_add_u32 s46, s8, 12288
    buffer_load_dwordx4 v[248:251], v11, s[12:15], s46 offen offset:2048 sc1
    s_add_u32 s46, s8, 12288
    v_add_f32 v216, s69, v216
    v_rcp_f32 v216, v216
    s_waitcnt vmcnt(6)
    v_cvt_pk_bf16_f32 v132, v232, v233
    v_cvt_pk_bf16_f32 v133, v234, v235
    v_mfma_f32_32x32x16_bf16 v[160:175], v[64:67], v[144:147], v[160:175]
    buffer_load_dwordx4 v[252:255], v11, s[12:15], s46 offen offset:3072 sc1
    s_add_u32 s46, s9, 4096
    buffer_load_dwordx4 a[220:223], v2, s[12:15], s46 offen offset:3072 sc1
    v_mul_f32_e64 v208, v208, v216
    v_mul_f32 v209, v209, v216
    v_mul_f32 v210, v210, v216
    v_mul_f32 v211, v211, v216
    v_mul_f32 v212, v212, v216
    v_mfma_f32_32x32x16_bf16 v[176:191], v[68:71], v[144:147], v[176:191]
    ds_read_b64_tr_b16 a[114:115], v9 offset:17408
    ds_read_b64_tr_b16 a[116:117], v9 offset:20480
    ds_read_b64_tr_b16 a[118:119], v9 offset:21504
    v_mul_f32 v213, v213, v216
    v_mul_f32 v214, v214, v216
    v_mul_f32_e64 v215, v215, v216
    v_cvt_pk_bf16_f32 v148, v208, v209
    v_cvt_pk_bf16_f32 v149, v210, v211
    v_cvt_pk_bf16_f32 v150, v212, v213
    v_cvt_pk_bf16_f32 v151, v214, v215
    s_waitcnt vmcnt(7)
    v_cvt_pk_bf16_f32 v134, v236, v237
    v_cvt_pk_bf16_f32 v135, v238, v239
    s_waitcnt vmcnt(6)
    s_nop 0
    v_mfma_f32_32x32x16_bf16 v[208:223], v[132:135], a[212:215], 0
    s_add_u32 s46, s9, 32768
    buffer_load_dwordx4 a[224:227], v2, s[12:15], s46 offen offset:0 sc1
    s_add_u32 s46, s9, 32768
    v_add_f32 v200, s69, v200
    v_rcp_f32 v200, v200
    s_waitcnt vmcnt(6)
    v_cvt_pk_bf16_f32 v136, v240, v241
    v_cvt_pk_bf16_f32 v137, v242, v243
    v_mfma_f32_32x32x16_bf16 v[160:175], v[72:75], v[148:151], v[160:175]
    buffer_load_dwordx4 a[228:231], v2, s[12:15], s46 offen offset:1024 sc1
    ds_read_b64_tr_b16 a[120:121], v8 offset:0
    ds_read_b64_tr_b16 a[122:123], v8 offset:1024
    v_mul_f32 v192, v192, v200
    v_mul_f32 v193, v193, v200
    v_mul_f32 v194, v194, v200
    v_mul_f32 v195, v195, v200
    v_mul_f32 v196, v196, v200
    v_mfma_f32_32x32x16_bf16 v[176:191], v[76:79], v[148:151], v[176:191]
    ds_read_b64_tr_b16 a[124:125], v8 offset:4096
    v_mul_f32 v197, v197, v200
    v_mul_f32 v198, v198, v200
    v_mul_f32 v199, v199, v200
    v_cvt_pk_bf16_f32 v144, v192, v193
    v_cvt_pk_bf16_f32 v145, v194, v195
    v_cvt_pk_bf16_f32 v146, v196, v197
    v_cvt_pk_bf16_f32 v147, v198, v199
    s_waitcnt vmcnt(6)
    v_cvt_pk_bf16_f32 v138, v244, v245
    v_cvt_pk_bf16_f32 v139, v246, v247
    s_waitcnt vmcnt(5)
    s_nop 0
    v_mfma_f32_32x32x16_bf16 v[192:207], v[136:139], a[216:219], 0
    s_add_u32 s46, s9, 32768
    buffer_load_dwordx4 a[232:235], v2, s[12:15], s46 offen offset:2048 sc1
    s_add_u32 s46, s9, 32768
    v_add_f32 v216, s69, v216
    v_rcp_f32 v216, v216
    s_waitcnt vmcnt(5)
    v_cvt_pk_bf16_f32 v140, v248, v249
    v_cvt_pk_bf16_f32 v141, v250, v251
    v_mfma_f32_32x32x16_bf16 v[160:175], v[80:83], v[144:147], v[160:175]
    buffer_load_dwordx4 a[236:239], v2, s[12:15], s46 offen offset:3072 sc1
    ds_read_b64_tr_b16 a[126:127], v8 offset:5120
    ds_read_b64_tr_b16 a[128:129], v8 offset:8192
    v_mul_f32_e64 v208, v208, v216
    v_mul_f32 v209, v209, v216
    v_mul_f32 v210, v210, v216
    v_mul_f32 v211, v211, v216
    v_mul_f32 v212, v212, v216
    v_mfma_f32_32x32x16_bf16 v[176:191], v[84:87], v[144:147], v[176:191]
    ds_read_b64_tr_b16 a[130:131], v8 offset:9216
    v_mul_f32 v213, v213, v216
    v_mul_f32 v214, v214, v216
    v_mul_f32 v215, v215, v216
    v_cvt_pk_bf16_f32 v148, v208, v209
    v_cvt_pk_bf16_f32 v149, v210, v211
    v_cvt_pk_bf16_f32 v150, v212, v213
    v_cvt_pk_bf16_f32 v151, v214, v215
    s_waitcnt vmcnt(5)
    v_cvt_pk_bf16_f32 v142, v252, v253
    v_cvt_pk_bf16_f32 v143, v254, v255
    s_waitcnt vmcnt(4)
    s_nop 0
    v_mfma_f32_32x32x16_bf16 v[208:223], v[140:143], a[220:223], 0
    s_add_u32 s46, s9, 36864
    buffer_load_dwordx4 a[240:243], v2, s[12:15], s46 offen offset:0 sc1
    s_add_u32 s46, s9, 36864
    v_add_f32 v200, s69, v200
    v_rcp_f32 v200, v200
    v_mfma_f32_32x32x16_bf16 v[160:175], v[88:91], v[148:151], v[160:175]
    buffer_load_dwordx4 a[244:247], v2, s[12:15], s46 offen offset:1024 sc1
    ds_read_b64_tr_b16 a[132:133], v8 offset:12288
    ds_read_b64_tr_b16 a[134:135], v8 offset:13312
    v_mul_f32 v192, v192, v200
    v_mul_f32 v193, v193, v200
    v_mul_f32 v194, v194, v200
    v_mul_f32 v195, v195, v200
    v_mul_f32 v196, v196, v200
    v_mfma_f32_32x32x16_bf16 v[176:191], v[92:95], v[148:151], v[176:191]
    ds_read_b64_tr_b16 a[136:137], v8 offset:16384
    v_mul_f32 v197, v197, v200
    v_mul_f32 v198, v198, v200
    v_mul_f32 v199, v199, v200
    v_cvt_pk_bf16_f32 v144, v192, v193
    v_cvt_pk_bf16_f32 v145, v194, v195
    v_cvt_pk_bf16_f32 v146, v196, v197
    v_cvt_pk_bf16_f32 v147, v198, v199
    s_waitcnt vmcnt(5)
    v_mfma_f32_32x32x16_bf16 v[192:207], v[112:115], a[224:227], 0
    s_add_u32 s46, s9, 36864
    buffer_load_dwordx4 a[248:251], v2, s[12:15], s46 offen offset:2048 sc1
    s_add_u32 s46, s9, 36864
    v_add_f32 v216, s69, v216
    v_rcp_f32_e64 v216, v216
    v_mfma_f32_32x32x16_bf16 v[160:175], v[96:99], v[144:147], v[160:175]
    buffer_load_dwordx4 a[252:255], v2, s[12:15], s46 offen offset:3072 sc1
    ds_read_b64_tr_b16 a[138:139], v8 offset:17408
    ds_read_b64_tr_b16 a[140:141], v8 offset:20480
    v_mul_f32 v208, v208, v216
    v_mul_f32 v209, v209, v216
    v_mul_f32 v210, v210, v216
    v_mul_f32 v211, v211, v216
    v_mul_f32 v212, v212, v216
    v_mfma_f32_32x32x16_bf16 v[176:191], v[100:103], v[144:147], v[176:191]
    ds_read_b64_tr_b16 a[142:143], v8 offset:21504
    v_mul_f32 v213, v213, v216
    v_mul_f32 v214, v214, v216
    v_mul_f32 v215, v215, v216
    v_cvt_pk_bf16_f32 v148, v208, v209
    v_cvt_pk_bf16_f32 v149, v210, v211
    v_cvt_pk_bf16_f32 v150, v212, v213
    v_cvt_pk_bf16_f32 v151, v214, v215
    s_waitcnt vmcnt(6)
    v_mfma_f32_32x32x16_bf16 v[208:223], v[116:119], a[228:231], 0
    s_add_u32 s61, s54, 1056768
    s_add_u32 s11, s61, s10
    s_add_u32 m0, s56, 90112
    v_add_f32 v200, s69, v200
    v_rcp_f32 v200, v200
    v_mfma_f32_32x32x16_bf16 v[160:175], v[104:107], v[148:151], v[160:175]
    buffer_load_dwordx4 v3, s[24:27], s61 offen offset:0 lds
    s_add_u32 m0, s56, 94080
    s_nop 0
    buffer_load_dwordx4 v3, s[24:27], s11 offen offset:128 lds
    v_mul_f32 v192, v192, v200
    v_mul_f32 v193, v193, v200
    v_mul_f32 v194, v194, v200
    v_mul_f32 v195, v195, v200
    v_mul_f32 v196, v196, v200
    v_mfma_f32_32x32x16_bf16 v[176:191], v[108:111], v[148:151], v[176:191]
    s_add_u32 m0, s56, 98048
    s_nop 0
    buffer_load_dwordx4 v3, s[24:27], s11 offen offset:256 lds
    v_mul_f32 v197, v197, v200
    v_mul_f32 v198, v198, v200
    v_mul_f32 v199, v199, v200
    v_cvt_pk_bf16_f32 v144, v192, v193
    v_cvt_pk_bf16_f32 v145, v194, v195
    v_cvt_pk_bf16_f32 v146, v196, v197
    v_cvt_pk_bf16_f32 v147, v198, v199
    s_waitcnt vmcnt(8)
    v_mfma_f32_32x32x16_bf16 v[192:207], v[120:123], a[232:235], 0
    s_add_u32 s61, s54, 1144832
    s_add_u32 s11, s61, s10
    s_add_u32 m0, s56, 102400
    v_add_f32 v216, s69, v216
    v_rcp_f32 v216, v216
    v_mfma_f32_32x32x16_bf16 v[224:239], v[48:51], v[144:147], 0
    buffer_load_dwordx4 v3, s[24:27], s61 offen offset:0 lds
    s_add_u32 m0, s56, 106368
    s_nop 0
    buffer_load_dwordx4 v3, s[24:27], s11 offen offset:128 lds
    v_mul_f32 v208, v208, v216
    v_mul_f32 v209, v209, v216
    v_mul_f32 v210, v210, v216
    v_mul_f32 v211, v211, v216
    v_mul_f32 v212, v212, v216
    v_mfma_f32_32x32x16_bf16 v[240:255], v[52:55], v[144:147], 0
    s_add_u32 m0, s56, 110336
    s_nop 0
    buffer_load_dwordx4 v3, s[24:27], s11 offen offset:256 lds
    v_mul_f32 v213, v213, v216
    v_mul_f32 v214, v214, v216
    v_mul_f32 v215, v215, v216
    v_cvt_pk_bf16_f32 v148, v208, v209
    v_cvt_pk_bf16_f32 v149, v210, v211
    v_cvt_pk_bf16_f32 v150, v212, v213
    v_cvt_pk_bf16_f32 v151, v214, v215
    s_waitcnt vmcnt(10)
    v_mfma_f32_32x32x16_bf16 v[208:223], v[124:127], a[236:239], 0
    s_add_u32 s61, s54, 1232896
    s_add_u32 s11, s61, s10
    s_add_u32 m0, s56, 139264
    v_add_f32 v200, s69, v200
    v_rcp_f32 v200, v200
    v_mfma_f32_32x32x16_bf16 v[224:239], v[56:59], v[148:151], v[224:239]
    buffer_load_dwordx4 v3, s[24:27], s61 offen offset:0 lds
    s_add_u32 m0, s56, 143232
    s_nop 0
    buffer_load_dwordx4 v3, s[24:27], s11 offen offset:128 lds
    v_mul_f32 v192, v192, v200
    v_mul_f32 v193, v193, v200
    v_mul_f32 v194, v194, v200
    v_mul_f32 v195, v195, v200
    v_mul_f32 v196, v196, v200
    v_mfma_f32_32x32x16_bf16 v[240:255], v[60:63], v[148:151], v[240:255]
    s_add_u32 m0, s56, 147200
    s_nop 0
    buffer_load_dwordx4 v3, s[24:27], s11 offen offset:256 lds
    ds_write_b128 v16, v[168:171] offset:0
    v_mul_f32 v197, v197, v200
    v_mul_f32 v198, v198, v200
    v_mul_f32 v199, v199, v200
    v_cvt_pk_bf16_f32 v144, v192, v193
    v_cvt_pk_bf16_f32 v145, v194, v195
    v_cvt_pk_bf16_f32 v146, v196, v197
    v_cvt_pk_bf16_f32 v147, v198, v199
    s_waitcnt vmcnt(12)
    v_mfma_f32_32x32x16_bf16 v[192:207], v[128:131], a[240:243], 0
    s_add_u32 s61, s54, 1320960
    s_add_u32 s11, s61, s10
    s_add_u32 m0, s56, 151552
    v_add_f32 v216, s69, v216
    v_rcp_f32 v216, v216
    v_mfma_f32_32x32x16_bf16 v[224:239], v[64:67], v[144:147], v[224:239]
    buffer_load_dwordx4 v3, s[24:27], s61 offen offset:0 lds
    s_add_u32 m0, s56, 155520
    s_nop 0
    buffer_load_dwordx4 v3, s[24:27], s11 offen offset:128 lds
    v_mul_f32 v208, v208, v216
    v_mul_f32 v209, v209, v216
    v_mul_f32 v210, v210, v216
    v_mul_f32 v211, v211, v216
    v_mul_f32 v212, v212, v216
    v_mfma_f32_32x32x16_bf16 v[240:255], v[68:71], v[144:147], v[240:255]
    s_add_u32 m0, s56, 159488
    s_nop 0
    buffer_load_dwordx4 v3, s[24:27], s11 offen offset:256 lds
    ds_write_b128 v16, v[172:175] offset:1024
    v_mul_f32 v213, v213, v216
    v_mul_f32 v214, v214, v216
    v_mul_f32 v215, v215, v216
    v_cvt_pk_bf16_f32 v148, v208, v209
    v_cvt_pk_bf16_f32 v149, v210, v211
    v_cvt_pk_bf16_f32 v150, v212, v213
    v_cvt_pk_bf16_f32 v151, v214, v215
    s_waitcnt vmcnt(14)
    v_mfma_f32_32x32x16_bf16 v[208:223], v[132:135], a[244:247], 0
    s_add_u32 s55, s67, 28672
    v_add_f32 v200, s69, v200
    v_rcp_f32_e64 v200, v200
    v_mfma_f32_32x32x16_bf16 v[224:239], v[72:75], v[148:151], v[224:239]
    buffer_load_dwordx4 a[192:195], v14, s[12:15], s55 offen offset:0 sc1
    v_mul_f32 v192, v192, v200
    v_mul_f32 v193, v193, v200
    v_mul_f32 v194, v194, v200
    v_mul_f32 v195, v195, v200
    v_mul_f32 v196, v196, v200
    v_mfma_f32_32x32x16_bf16 v[240:255], v[76:79], v[148:151], v[240:255]
    ds_write_b128 v17, v[176:179] offset:0
    v_mul_f32 v197, v197, v200
    v_mul_f32 v198, v198, v200
    v_mul_f32 v199, v199, v200
    v_cvt_pk_bf16_f32 v144, v192, v193
    v_cvt_pk_bf16_f32 v145, v194, v195
    v_cvt_pk_bf16_f32 v146, v196, v197
    v_cvt_pk_bf16_f32 v147, v198, v199
    s_waitcnt vmcnt(14)
    v_mfma_f32_32x32x16_bf16 v[192:207], v[136:139], a[248:251], 0
    buffer_load_dwordx4 a[196:199], v15, s[12:15], s55 offen offset:0 sc1
    ds_write_b128 v17, v[180:183] offset:1024
    s_lshl_b32 s7, s49, 16
    v_add_f32 v216, s69, v216
    v_rcp_f32 v216, v216
    v_mfma_f32_32x32x16_bf16 v[224:239], v[80:83], v[144:147], v[224:239]
    s_add_u32 s7, s7, s58
    s_add_u32 s7, s7, 3637248
    s_lshl_b32 s81, s49, 14
    v_mul_f32 v208, v208, v216
    v_mul_f32 v209, v209, v216
    v_mul_f32 v210, v210, v216
    v_mul_f32 v211, v211, v216
    v_mul_f32_e64 v212, v212, v216
    v_mfma_f32_32x32x16_bf16 v[240:255], v[84:87], v[144:147], v[240:255]
    s_add_u32 s81, s81, s58
    s_add_u32 s81, s81, 5734400
    v_mul_f32 v213, v213, v216
    v_mul_f32 v214, v214, v216
    v_mul_f32 v215, v215, v216
    v_cvt_pk_bf16_f32 v148, v208, v209
    v_cvt_pk_bf16_f32 v149, v210, v211
    v_cvt_pk_bf16_f32 v150, v212, v213
    v_cvt_pk_bf16_f32 v151, v214, v215
    s_waitcnt vmcnt(14)
    v_mfma_f32_32x32x16_bf16 v[208:223], v[140:143], a[252:255], 0
    buffer_load_dwordx4 a[200:203], v14, s[12:15], s55 offen offset:2048 sc1
    v_add_f32 v200, s69, v200
    v_rcp_f32 v200, v200
    v_mfma_f32_32x32x16_bf16 v[224:239], v[88:91], v[148:151], v[224:239]
    ds_write_b128 v18, v[184:187] offset:0
    v_mul_f32 v192, v192, v200
    v_mul_f32 v193, v193, v200
    v_mul_f32 v194, v194, v200
    v_mul_f32 v195, v195, v200
    v_mul_f32 v196, v196, v200
    v_mfma_f32_32x32x16_bf16 v[240:255], v[92:95], v[148:151], v[240:255]
    v_cmp_eq_u32 vcc, s72, v7
    s_nop 1
    s_cmp_eq_u32 vcc_lo, -1
    s_cselect_b32 s72, 1, 0
    s_add_u32 s45, s4, 32768
    v_mul_f32 v197, v197, v200
    v_mul_f32 v198, v198, v200
L_hop3:
    s_cbranch_execz L_back1
    v_mul_f32 v199, v199, v200
    v_cvt_pk_bf16_f32 v144, v192, v193
    v_cvt_pk_bf16_f32 v145, v194, v195
    v_cvt_pk_bf16_f32 v146, v196, v197
    v_cvt_pk_bf16_f32 v147, v198, v199
    buffer_load_dwordx4 a[204:207], v15, s[12:15], s55 offen offset:2048 sc1
    v_add_f32 v216, s69, v216
    v_rcp_f32 v216, v216
    v_mfma_f32_32x32x16_bf16 v[224:239], v[96:99], v[144:147], v[224:239]
    ds_write_b128 v18, v[188:191] offset:1024
    v_mul_f32 v208, v208, v216
    v_mul_f32 v209, v209, v216
    v_mul_f32 v210, v210, v216
    v_mul_f32 v211, v211, v216
    v_mul_f32 v212, v212, v216
    v_mfma_f32_32x32x16_bf16 v[240:255], v[100:103], v[144:147], v[240:255]
    v_mul_f32 v213, v213, v216
    v_mul_f32 v214, v214, v216
    v_mul_f32 v215, v215, v216
    v_cvt_pk_bf16_f32 v148, v208, v209
    v_cvt_pk_bf16_f32 v149, v210, v211
    v_cvt_pk_bf16_f32 v150, v212, v213
    v_cvt_pk_bf16_f32 v151, v214, v215
    s_nop 1
    v_mfma_f32_32x32x16_bf16 v[224:239], v[104:107], v[148:151], v[224:239]
    v_mfma_f32_32x32x16_bf16 v[240:255], v[108:111], v[148:151], v[240:255]
    v_lshlrev_b32 v72, 16, v24
    v_and_b32 v73, 0xffff0000, v24
    v_lshlrev_b32_e64 v74, 16, v25
    v_and_b32 v75, 0xffff0000, v25
    v_lshlrev_b32 v76, 16, v26
    v_and_b32 v77, 0xffff0000, v26
    v_lshlrev_b32 v78, 16, v27
    v_and_b32 v79, 0xffff0000, v27
    s_nop 2
    ds_write_b128 v16, v[232:235] offset:32768
    v_lshlrev_b32 v80, 16, v28
    v_and_b32 v81, 0xffff0000, v28
    v_lshlrev_b32_e64 v82, 16, v29
    v_and_b32 v83, 0xffff0000, v29
    s_add_u32 s55, s67, 32768
    buffer_load_dwordx4 a[208:211], v14, s[12:15], s55 offen offset:0 sc1
    ds_write_b128 v16, v[236:239] offset:33792
    v_lshlrev_b32 v84, 16, v30
    v_and_b32 v85, 0xffff0000, v30
    v_lshlrev_b32 v86, 16, v31
    v_and_b32 v87, 0xffff0000, v31
    buffer_load_dwordx4 a[212:215], v15, s[12:15], s55 offen offset:0 sc1
    ds_write_b128 v17, v[240:243] offset:32768
    v_pk_add_f32 v[160:161], v[160:161], v[72:73]
    v_pk_add_f32 v[162:163], v[162:163], v[74:75]
    v_pk_add_f32 v[164:165], v[164:165], v[76:77]
    v_pk_add_f32 v[166:167], v[166:167], v[78:79]
    buffer_load_dwordx4 a[216:219], v14, s[12:15], s55 offen offset:2048 sc1
    ds_write_b128 v17, v[244:247] offset:33792
    v_pk_add_f32 v[224:225], v[224:225], v[80:81]
    v_pk_add_f32 v[226:227], v[226:227], v[82:83]
    v_pk_add_f32 v[228:229], v[228:229], v[84:85]
    v_pk_add_f32 v[230:231], v[230:231], v[86:87]
    buffer_load_dwordx4 a[220:223], v15, s[12:15], s55 offen offset:2048 sc1
    ds_write_b128 v18, v[248:251] offset:32768
    v_mov_b32_e64 v88, 0
    v_mov_b32 v89, 0
    v_mov_b32 v90, 0
    v_mov_b32 v91, 0
    ds_write_b128 v18, v[252:255] offset:33792
    s_waitcnt vmcnt(8)
    s_waitcnt lgkmcnt(0)
    s_barrier
    ds_read_b128 v[192:195], v19 offset:2048
    ds_read_b128 v[196:199], v19 offset:3072
    ds_read_b128 v[200:203], v19 offset:4096
    ds_read_b128 v[204:207], v19 offset:5120
    ds_read_b128 v[208:211], v19 offset:6144
    ds_read_b128 v[212:215], v19 offset:7168
    ds_read_b128 v[48:51], v19 offset:34816
    ds_read_b128 v[52:55], v19 offset:35840
    ds_read_b128 v[56:59], v19 offset:36864
    ds_read_b128 v[60:63], v19 offset:37888
    ds_read_b128 v[64:67], v19 offset:38912
    ds_read_b128 v[68:71], v19 offset:39936
    s_waitcnt lgkmcnt(11)
    v_pk_add_f32 v[160:161], v[160:161], v[192:193]
    v_pk_add_f32 v[162:163], v[162:163], v[194:195]
    s_waitcnt lgkmcnt(10)
    v_pk_add_f32 v[164:165], v[164:165], v[196:197]
    v_pk_add_f32 v[166:167], v[166:167], v[198:199]
    s_waitcnt lgkmcnt(9)
    v_pk_add_f32 v[160:161], v[160:161], v[200:201]
    v_pk_add_f32 v[162:163], v[162:163], v[202:203]
    s_waitcnt lgkmcnt(8)
    v_pk_add_f32 v[164:165], v[164:165], v[204:205]
    v_pk_add_f32 v[166:167], v[166:167], v[206:207]
    s_waitcnt lgkmcnt(7)
    v_pk_add_f32 v[160:161], v[160:161], v[208:209]
    v_pk_add_f32 v[162:163], v[162:163], v[210:211]
    s_waitcnt lgkmcnt(6)
    v_pk_add_f32 v[164:165], v[164:165], v[212:213]
    v_pk_add_f32 v[166:167], v[166:167], v[214:215]
    v_cvt_pk_bf16_f32 v144, v160, v161
    v_cvt_pk_bf16_f32 v145, v162, v163
    v_cvt_pk_bf16_f32 v146, v164, v165
    v_cvt_pk_bf16_f32 v147, v166, v167
    buffer_store_dwordx4 v[144:147], v20, s[12:15], s4 offen sc1
    s_waitcnt lgkmcnt(5)
    v_pk_add_f32 v[224:225], v[224:225], v[48:49]
    v_pk_add_f32 v[226:227], v[226:227], v[50:51]
    s_waitcnt lgkmcnt(4)
    v_pk_add_f32 v[228:229], v[228:229], v[52:53]
    v_pk_add_f32 v[230:231], v[230:231], v[54:55]
    s_waitcnt lgkmcnt(3)
    v_pk_add_f32 v[224:225], v[224:225], v[56:57]
    v_pk_add_f32 v[226:227], v[226:227], v[58:59]
    s_waitcnt lgkmcnt(2)
    v_pk_add_f32 v[228:229], v[228:229], v[60:61]
    v_pk_add_f32 v[230:231], v[230:231], v[62:63]
    s_waitcnt lgkmcnt(1)
    v_pk_add_f32 v[224:225], v[224:225], v[64:65]
    v_pk_add_f32 v[226:227], v[226:227], v[66:67]
    s_waitcnt lgkmcnt(0)
    v_pk_add_f32 v[228:229], v[228:229], v[68:69]
    v_pk_add_f32 v[230:231], v[230:231], v[70:71]
    v_cvt_pk_bf16_f32 v148, v224, v225
    v_cvt_pk_bf16_f32 v149, v226, v227
    v_cvt_pk_bf16_f32 v150, v228, v229
    v_cvt_pk_bf16_f32 v151, v230, v231
    buffer_store_dwordx4 v[148:151], v20, s[12:15], s45 offen sc1
    v_dot2_f32_bf16 v88, v144, s70, v88
    v_dot2_f32_bf16 v89, v144, v144, v89
    v_dot2_f32_bf16 v90, v148, s70, v90
    v_dot2_f32_bf16 v91, v148, v148, v91
    v_dot2_f32_bf16 v88, v145, s70, v88
    v_dot2_f32_bf16 v89, v145, v145, v89
    v_dot2_f32_bf16 v90, v149, s70, v90
    v_dot2_f32_bf16 v91, v149, v149, v91
    v_dot2_f32_bf16 v88, v146, s70, v88
    v_dot2_f32_bf16 v89, v146, v146, v89
    v_dot2_f32_bf16 v90, v150, s70, v90
    v_dot2_f32_bf16 v91, v150, v150, v91
    v_dot2_f32_bf16 v88, v147, s70, v88
    v_dot2_f32_bf16 v89, v147, v147, v89
    v_dot2_f32_bf16 v90, v151, s70, v90
    v_dot2_f32_bf16 v91, v151, v151, v91
    v_lshlrev_b32 v32, 16, v144
    v_and_b32 v33, 0xffff0000, v144
    v_lshlrev_b32 v34, 16, v145
    v_and_b32 v35, 0xffff0000, v145
    v_permlane32_swap_b32 v88, v90
    v_permlane32_swap_b32 v89, v91
    v_pk_add_f32 v[88:89], v[88:89], v[90:91]
    buffer_store_dwordx2 v[88:89], v21, s[12:15], s5 offen sc1
    ds_read_b64_tr_b16 a[144:145], v8 offset:24576
    ds_read_b64_tr_b16 a[146:147], v8 offset:25600
    ds_read_b64_tr_b16 a[148:149], v8 offset:28672
    ds_read_b64_tr_b16 a[150:151], v8 offset:29696
    ds_read_b64_tr_b16 a[152:153], v8 offset:32768
    ds_read_b64_tr_b16 a[154:155], v8 offset:33792
    ds_read_b64_tr_b16 a[156:157], v8 offset:36864
    ds_read_b64_tr_b16 a[158:159], v8 offset:37888
    ds_read_b64_tr_b16 a[160:161], v8 offset:40960
    ds_read_b64_tr_b16 a[162:163], v8 offset:41984
    ds_read_b64_tr_b16 a[164:165], v8 offset:45056
    ds_read_b64_tr_b16 a[166:167], v8 offset:46080
    ds_read_b64_tr_b16 a[168:169], v9 offset:24576
    ds_read_b64_tr_b16 a[170:171], v9 offset:25600
    ds_read_b64_tr_b16 a[172:173], v9 offset:28672
    ds_read_b64_tr_b16 a[174:175], v9 offset:29696
    ds_read_b64_tr_b16 a[176:177], v9 offset:32768
    ds_read_b64_tr_b16 a[178:179], v9 offset:33792
    ds_read_b64_tr_b16 a[180:181], v9 offset:36864
    ds_read_b64_tr_b16 a[182:183], v9 offset:37888
    ds_read_b64_tr_b16 a[184:185], v9 offset:40960
    ds_read_b64_tr_b16 a[186:187], v9 offset:41984
    ds_read_b64_tr_b16 a[188:189], v9 offset:45056
    ds_read_b64_tr_b16 a[190:191], v9 offset:46080
    v_lshlrev_b32 v36, 16, v146
    v_and_b32 v37, 0xffff0000, v146
    v_lshlrev_b32 v38, 16, v147
    v_and_b32 v39, 0xffff0000, v147
    v_lshlrev_b32 v24, 16, v148
    v_and_b32 v25, 0xffff0000, v148
    v_lshlrev_b32 v26, 16, v149
    v_and_b32 v27, 0xffff0000, v149
    v_lshlrev_b32 v28, 16, v150
    v_and_b32 v29, 0xffff0000, v150
    v_lshlrev_b32 v30, 16, v151
    v_and_b32 v31, 0xffff0000, v151
    v_lshrrev_b32 v170, 4, v1
    v_lshlrev_b32 v170, 3, v170
    v_lshrrev_b32 v171, 5, v1
    v_lshlrev_b32 v171, 3, v171
    s_lshl_b32 s44, s51, 5
    s_lshl_b32 s45, s50, 5
    buffer_load_dwordx2 v[160:161], v170, s[32:35], s44 offen offset:0
    buffer_load_dwordx2 v[162:163], v170, s[32:35], s44 offen offset:128
    buffer_load_dwordx2 v[164:165], v170, s[32:35], s44 offen offset:256
    buffer_load_dwordx2 v[166:167], v171, s[36:39], s45 offen offset:0
    buffer_load_dwordx2 v[168:169], v171, s[36:39], s45 offen offset:16
    v_mfma_f32_16x16x32_bf16 v[224:227], a[96:99], v[40:43], v[44:47]
    s_add_u32 s55, s67, 0
    v_and_b32 v13, 56, v1
    v_and_b32_e64 v12, 7, v1
    v_mfma_f32_16x16x32_bf16 v[228:231], a[100:103], v[40:43], v[152:155]
    buffer_load_dwordx4 v[48:51], v14, s[12:15], s55 offen offset:0 sc1
    v_mfma_f32_16x16x32_bf16 v[232:235], a[104:107], v[40:43], v[156:159]
    v_mul_u32_u24 v12, 1088, v12
    v_add_u32 v12, v12, v13
    s_lshl_b32 s44, s47, 6
    v_mfma_f32_16x16x32_bf16 v[224:227], a[108:111], v[40:43], v[224:227]
    s_add_u32 s45, s44, 69632
    v_add_u32 v12, s45, v12
    s_add_u32 s44, s44, 65536
    v_mfma_f32_16x16x32_bf16 v[228:231], a[112:115], v[40:43], v[228:231]
    v_add_u32 v13, s44, v13
    v_mov_b32 v20, 0xc0135761
    v_mfma_f32_16x16x32_bf16 v[232:235], a[116:119], v[40:43], v[232:235]
    buffer_load_dwordx4 v[52:55], v15, s[12:15], s55 offen offset:0 sc1
    v_mfma_f32_16x16x32_bf16 v[224:227], a[120:123], v[40:43], v[224:227]
    v_mov_b32 v21, 0xc0135761
    v_and_b32 v11, 15, v1
    v_mfma_f32_16x16x32_bf16 v[228:231], a[124:127], v[40:43], v[228:231]
    v_lshlrev_b32 v11, 3, v11
    v_add_u32 v11, 65536, v11
    v_mfma_f32_16x16x32_bf16 v[232:235], a[128:131], v[40:43], v[232:235]
    v_mfma_f32_16x16x32_bf16 v[224:227], a[132:135], v[40:43], v[224:227]
    v_mfma_f32_16x16x32_bf16 v[228:231], a[136:139], v[40:43], v[228:231]
    v_mfma_f32_16x16x32_bf16 v[232:235], a[140:143], v[40:43], v[232:235]
    s_waitcnt lgkmcnt(15)
    v_mfma_f32_16x16x32_bf16 v[224:227], a[144:147], v[40:43], v[224:227]
    v_mfma_f32_16x16x32_bf16 v[228:231], a[148:151], v[40:43], v[228:231]
    v_mfma_f32_16x16x32_bf16 v[232:235], a[152:155], v[40:43], v[232:235]
    v_mfma_f32_16x16x32_bf16 v[224:227], a[156:159], v[40:43], v[224:227]
    s_waitcnt lgkmcnt(14)
    v_mfma_f32_16x16x32_bf16 v[228:231], a[160:163], v[40:43], v[228:231]
    s_waitcnt lgkmcnt(12)
    v_mfma_f32_16x16x32_bf16 v[232:235], a[164:167], v[40:43], v[232:235]
    s_waitcnt lgkmcnt(10)
    v_mfma_f32_16x16x32_bf16 v[224:227], a[168:171], v[40:43], v[224:227]
    s_waitcnt lgkmcnt(8)
    v_mfma_f32_16x16x32_bf16 v[228:231], a[172:175], v[40:43], v[228:231]
    s_waitcnt lgkmcnt(6)
    v_mfma_f32_16x16x32_bf16 v[232:235], a[176:179], v[40:43], v[232:235]
    s_waitcnt lgkmcnt(4)
    v_mfma_f32_16x16x32_bf16 v[224:227], a[180:183], v[40:43], v[224:227]
    s_waitcnt lgkmcnt(2)
    v_mfma_f32_16x16x32_bf16 v[228:231], a[184:187], v[40:43], v[228:231]
    s_waitcnt lgkmcnt(0)
    v_mfma_f32_16x16x32_bf16 v[232:235], a[188:191], v[40:43], v[232:235]
    s_waitcnt vmcnt(7)
    s_barrier
    s_cmp_lg_u32 s47, 3
    s_cbranch_scc1 L_nf3
    s_cmp_eq_u32 s72, 0
    s_cbranch_scc1 L_ff3
    buffer_store_dword v22, v23, s[12:15], s80 offen offset:0
    s_branch L_nf3
L_ff3:
    buffer_store_dword v22, v23, s[12:15], s80 offen offset:0 sc1
L_nf3:
    s_waitcnt vmcnt(3)
    v_lshlrev_b32 v212, 16, v166
    v_and_b32 v213, 0xffff0000, v166
    v_lshlrev_b32_e64 v214, 16, v167
    v_and_b32 v215, 0xffff0000, v167
    s_waitcnt vmcnt(2)
    v_lshlrev_b32 v216, 16, v168
    v_and_b32 v217, 0xffff0000, v168
    v_lshlrev_b32_e64 v218, 16, v169
    v_and_b32 v219, 0xffff0000, v169
    v_pk_add_f32 v[32:33], v[32:33], v[212:213]
    v_pk_add_f32 v[34:35], v[34:35], v[214:215]
    v_pk_add_f32 v[36:37], v[36:37], v[216:217]
    v_pk_add_f32 v[38:39], v[38:39], v[218:219]
    v_pk_add_f32 v[24:25], v[24:25], v[212:213]
    v_pk_add_f32 v[26:27], v[26:27], v[214:215]
    v_pk_add_f32 v[28:29], v[28:29], v[216:217]
    v_pk_add_f32 v[30:31], v[30:31], v[218:219]
    v_lshlrev_b32 v236, 16, v160
    v_and_b32 v237, 0xffff0000, v160
    v_lshlrev_b32 v238, 16, v161
    v_and_b32 v239, 0xffff0000, v161
    v_lshlrev_b32 v240, 16, v162
    v_and_b32 v241, 0xffff0000, v162
    v_lshlrev_b32 v242, 16, v163
    v_and_b32 v243, 0xffff0000, v163
    v_lshlrev_b32 v244, 16, v164
    v_and_b32 v245, 0xffff0000, v164
    v_lshlrev_b32 v246, 16, v165
    v_and_b32 v247, 0xffff0000, v165
    buffer_load_dword v4, v10, s[12:15], s66 offen offset:0 sc1
    s_waitcnt vmcnt(0)
    v_cmp_ne_u32 vcc, 0, v4
    s_nop 1
    s_cmp_eq_u32 vcc_lo, 255
    s_cbranch_scc1 L_ok4
    s_mov_b32 s45, 0
L_spin4:
    buffer_load_dword v4, v10, s[12:15], s66 offen offset:0 sc1
    s_add_u32 s45, s45, 1
    s_waitcnt vmcnt(0)
    v_cmp_ne_u32 vcc, 0, v4
    s_cmp_ge_u32 s45, 262144
    s_cbranch_scc1 L_ok4
    s_nop 1
    s_nop 1
    s_cmp_eq_u32 vcc_lo, 255
    s_cbranch_scc0 L_spin4
L_ok4:
    s_add_u32 m0, s58, 0
    s_add_u32 s46, s7, 0
    buffer_load_dwordx4 v2, s[12:15], s46 offen offset:0 sc1 lds
    buffer_load_dwordx4 v2, s[12:15], s46 offen offset:1024 sc1 lds
    buffer_load_dwordx4 v2, s[12:15], s46 offen offset:2048 sc1 lds
    buffer_load_dwordx4 v2, s[12:15], s46 offen offset:3072 sc1 lds
    s_mul_i32 s44, s47, 4352
    s_add_u32 m0, s44, 69632
    s_nop 0
    buffer_load_dwordx4 v2, s[12:15], s81 offen offset:0 sc1 lds
    s_add_u32 m0, s44, 69696
    s_nop 0
    buffer_load_dwordx4 v2, s[12:15], s81 offen offset:1024 sc1 lds
    s_add_u32 m0, s44, 69760
    s_nop 0
    buffer_load_dwordx4 v2, s[12:15], s81 offen offset:2048 sc1 lds
    s_add_u32 m0, s44, 69824
    s_nop 0
    buffer_load_dwordx4 v2, s[12:15], s81 offen offset:3072 sc1 lds
    s_add_u32 m0, s58, 16384
    s_add_u32 s46, s7, 16384
    buffer_load_dwordx4 v2, s[12:15], s46 offen offset:0 sc1 lds
    buffer_load_dwordx4 v2, s[12:15], s46 offen offset:1024 sc1 lds
    buffer_load_dwordx4 v2, s[12:15], s46 offen offset:2048 sc1 lds
    buffer_load_dwordx4 v2, s[12:15], s46 offen offset:3072 sc1 lds
    s_add_u32 m0, s58, 32768
    s_add_u32 s46, s7, 32768
    buffer_load_dwordx4 v2, s[12:15], s46 offen offset:0 sc1 lds
    buffer_load_dwordx4 v2, s[12:15], s46 offen offset:1024 sc1 lds
    buffer_load_dwordx4 v2, s[12:15], s46 offen offset:2048 sc1 lds
    buffer_load_dwordx4 v2, s[12:15], s46 offen offset:3072 sc1 lds
    s_add_u32 m0, s58, 49152
    s_add_u32 s46, s7, 49152
    buffer_load_dwordx4 v2, s[12:15], s46 offen offset:0 sc1 lds
    buffer_load_dwordx4 v2, s[12:15], s46 offen offset:1024 sc1 lds
    buffer_load_dwordx4 v2, s[12:15], s46 offen offset:2048 sc1 lds
    buffer_load_dwordx4 v2, s[12:15], s46 offen offset:3072 sc1 lds
    s_waitcnt vmcnt(16)
    s_barrier
    ds_read_b128 v[184:187], v2 offset:0
    ds_read_b128 v[188:191], v2 offset:1024
    ds_read_b128 v[192:195], v2 offset:2048
    s_waitcnt lgkmcnt(2)
    v_mfma_f32_16x16x32_bf16 v[160:163], a[0:3], v[184:187], 0
    ds_read_b128 v[196:199], v2 offset:3072
    s_waitcnt lgkmcnt(2)
    v_mfma_f32_16x16x32_bf16 v[164:167], a[4:7], v[184:187], 0
    buffer_load_dwordx4 v[56:59], v14, s[12:15], s55 offen offset:2048 sc1
    v_mfma_f32_16x16x32_bf16 v[168:171], a[8:11], v[184:187], 0
    v_mfma_f32_16x16x32_bf16 v[160:163], a[12:15], v[188:191], v[160:163]
    ds_read_b128 v[184:187], v2 offset:4096
    s_waitcnt lgkmcnt(2)
    v_mfma_f32_16x16x32_bf16 v[164:167], a[16:19], v[188:191], v[164:167]
    v_mfma_f32_16x16x32_bf16 v[168:171], a[20:23], v[188:191], v[168:171]
    buffer_load_dwordx4 v[60:63], v15, s[12:15], s55 offen offset:2048 sc1
    v_mfma_f32_16x16x32_bf16 v[160:163], a[24:27], v[192:195], v[160:163]
    ds_read_b128 v[188:191], v2 offset:5120
    s_waitcnt lgkmcnt(2)
    v_mfma_f32_16x16x32_bf16 v[164:167], a[28:31], v[192:195], v[164:167]
    s_add_u32 s55, s67, 4096
    v_mfma_f32_16x16x32_bf16 v[168:171], a[32:35], v[192:195], v[168:171]
    v_mfma_f32_16x16x32_bf16 v[160:163], a[36:39], v[196:199], v[160:163]
    ds_read_b128 v[192:195], v2 offset:6144
    s_waitcnt lgkmcnt(2)
    v_mfma_f32_16x16x32_bf16 v[164:167], a[40:43], v[196:199], v[164:167]
    buffer_load_dwordx4 v[64:67], v14, s[12:15], s55 offen offset:0 sc1
    v_mfma_f32_16x16x32_bf16 v[168:171], a[44:47], v[196:199], v[168:171]
    v_mfma_f32_16x16x32_bf16 v[160:163], a[48:51], v[184:187], v[160:163]
    ds_read_b128 v[196:199], v2 offset:7168
    s_waitcnt lgkmcnt(2)
    v_mfma_f32_16x16x32_bf16 v[164:167], a[52:55], v[184:187], v[164:167]
    s_waitcnt vmcnt(15)
    s_barrier
    v_mfma_f32_16x16x32_bf16 v[168:171], a[56:59], v[184:187], v[168:171]
    ds_read_b64 v[200:201], v12 offset:0
    ds_read_b64 v[202:203], v12 offset:256
    v_mfma_f32_16x16x32_bf16 v[160:163], a[60:63], v[188:191], v[160:163]
    ds_read_b64 v[204:205], v12 offset:512
    ds_read_b64 v[206:207], v12 offset:768
    v_mfma_f32_16x16x32_bf16 v[164:167], a[64:67], v[188:191], v[164:167]
    ds_read_b64 v[152:153], v12 offset:8704
    ds_read_b64 v[154:155], v12 offset:8960
    v_mfma_f32_16x16x32_bf16 v[168:171], a[68:71], v[188:191], v[168:171]
    ds_read_b64 v[156:157], v12 offset:9216
    ds_read_b64 v[158:159], v12 offset:9472
    s_waitcnt lgkmcnt(9)
    v_mfma_f32_16x16x32_bf16 v[160:163], a[72:75], v[192:195], v[160:163]
    ds_read_b128 v[184:187], v2 offset:8192
    s_waitcnt lgkmcnt(2)
    v_mfma_f32_16x16x32_bf16 v[164:167], a[76:79], v[192:195], v[164:167]
    ds_read_b128 v[188:191], v2 offset:9216
    s_waitcnt lgkmcnt(2)
    v_mfma_f32_16x16x32_bf16 v[168:171], a[80:83], v[192:195], v[168:171]
    buffer_load_dwordx4 v[68:71], v15, s[12:15], s55 offen offset:0 sc1
    v_mfma_f32_16x16x32_bf16 v[160:163], a[84:87], v[196:199], v[160:163]
    ds_read_b128 v[192:195], v2 offset:10240
    s_waitcnt lgkmcnt(2)
    v_mfma_f32_16x16x32_bf16 v[164:167], a[88:91], v[196:199], v[164:167]
    v_add_f32 v200, v200, v202
    v_add_f32 v152, v152, v154
    v_mfma_f32_16x16x32_bf16 v[168:171], a[92:95], v[196:199], v[168:171]
    v_add_f32_e64 v201, v201, v203
    v_add_f32 v153, v153, v155
    v_mfma_f32_16x16x32_bf16 v[160:163], a[96:99], v[184:187], v[160:163]
    ds_read_b128 v[196:199], v2 offset:11264
    s_waitcnt lgkmcnt(2)
    v_mfma_f32_16x16x32_bf16 v[164:167], a[100:103], v[184:187], v[164:167]
    buffer_load_dwordx4 v[72:75], v14, s[12:15], s55 offen offset:2048 sc1
    v_mfma_f32_16x16x32_bf16 v[168:171], a[104:107], v[184:187], v[168:171]
    v_add_f32 v204, v204, v206
    v_add_f32 v156, v156, v158
    v_mfma_f32_16x16x32_bf16 v[160:163], a[108:111], v[188:191], v[160:163]
    ds_read_b128 v[184:187], v2 offset:12288
    s_waitcnt lgkmcnt(2)
    v_mfma_f32_16x16x32_bf16 v[164:167], a[112:115], v[188:191], v[164:167]
    v_add_f32 v205, v205, v207
    v_add_f32 v157, v157, v159
    v_mfma_f32_16x16x32_bf16 v[168:171], a[116:119], v[188:191], v[168:171]
    buffer_load_dwordx4 v[76:79], v15, s[12:15], s55 offen offset:2048 sc1
    v_mfma_f32_16x16x32_bf16 v[160:163], a[120:123], v[192:195], v[160:163]
    ds_read_b128 v[188:191], v2 offset:13312
    s_waitcnt lgkmcnt(2)
    v_mfma_f32_16x16x32_bf16 v[164:167], a[124:127], v[192:195], v[164:167]
    s_add_u32 s55, s67, 8192
    v_add_f32 v200, v200, v204
    v_add_f32 v152, v152, v156
    v_mfma_f32_16x16x32_bf16 v[168:171], a[128:131], v[192:195], v[168:171]
    v_add_f32 v201, v201, v205
    v_add_f32 v153, v153, v157
    v_mfma_f32_16x16x32_bf16 v[160:163], a[132:135], v[196:199], v[160:163]
    ds_read_b128 v[192:195], v2 offset:14336
    s_waitcnt lgkmcnt(2)
    v_mfma_f32_16x16x32_bf16 v[164:167], a[136:139], v[196:199], v[164:167]
    buffer_load_dwordx4 v[80:83], v14, s[12:15], s55 offen offset:0 sc1
    v_mfma_f32_16x16x32_bf16 v[168:171], a[140:143], v[196:199], v[168:171]
    v_add_f32 v200, v200, v200 quad_perm:[1,0,3,2] row_mask:0xf bank_mask:0xf
    v_add_f32 v152, v152, v152 quad_perm:[1,0,3,2] row_mask:0xf bank_mask:0xf
    v_mfma_f32_16x16x32_bf16 v[160:163], a[144:147], v[184:187], v[160:163]
    ds_read_b128 v[196:199], v2 offset:15360
    s_waitcnt lgkmcnt(2)
    v_mfma_f32_16x16x32_bf16 v[164:167], a[148:151], v[184:187], v[164:167]
    v_add_f32 v201, v201, v201 quad_perm:[1,0,3,2] row_mask:0xf bank_mask:0xf
    v_add_f32 v153, v153, v153 quad_perm:[1,0,3,2] row_mask:0xf bank_mask:0xf
    v_mfma_f32_16x16x32_bf16 v[168:171], a[152:155], v[184:187], v[168:171]
    v_add_f32 v200, v200, v200 quad_perm:[2,3,0,1] row_mask:0xf bank_mask:0xf
    v_add_f32 v152, v152, v152 quad_perm:[2,3,0,1] row_mask:0xf bank_mask:0xf
    v_mfma_f32_16x16x32_bf16 v[160:163], a[156:159], v[188:191], v[160:163]
    v_add_f32 v201, v201, v201 quad_perm:[2,3,0,1] row_mask:0xf bank_mask:0xf
    v_add_f32 v153, v153, v153 quad_perm:[2,3,0,1] row_mask:0xf bank_mask:0xf
    v_mfma_f32_16x16x32_bf16 v[164:167], a[160:163], v[188:191], v[164:167]
    v_add_f32 v200, v200, v200 row_half_mirror row_mask:0xf bank_mask:0xf
    v_add_f32 v152, v152, v152 row_half_mirror row_mask:0xf bank_mask:0xf
    v_mfma_f32_16x16x32_bf16 v[168:171], a[164:167], v[188:191], v[168:171]
    v_add_f32 v201, v201, v201 row_half_mirror row_mask:0xf bank_mask:0xf
    v_add_f32 v153, v153, v153 row_half_mirror row_mask:0xf bank_mask:0xf
    s_waitcnt lgkmcnt(1)
    v_mfma_f32_16x16x32_bf16 v[160:163], a[168:171], v[192:195], v[160:163]
    v_mul_f32 v200, 0x3b000000, v200
    v_mul_f32 v152, 0x3b000000, v152
    v_mfma_f32_16x16x32_bf16 v[164:167], a[172:175], v[192:195], v[164:167]
    v_mul_f32 v201, 0x3b000000, v201
    v_mul_f32 v153, 0x3b000000, v153
    v_mfma_f32_16x16x32_bf16 v[168:171], a[176:179], v[192:195], v[168:171]
    v_fma_f32 v201, -v200, v200, v201
    v_fma_f32 v153, -v152, v152, v153
    s_waitcnt lgkmcnt(0)
    v_mfma_f32_16x16x32_bf16 v[160:163], a[180:183], v[196:199], v[160:163]
    v_max_f32 v201, 0, v201
    v_max_f32 v153, 0, v153
    v_mfma_f32_16x16x32_bf16 v[164:167], a[184:187], v[196:199], v[164:167]
    v_add_f32 v202, s71, v201
    v_add_f32 v154, s71, v153
    v_mfma_f32_16x16x32_bf16 v[168:171], a[188:191], v[196:199], v[168:171]
    v_rsq_f32 v202, v202
    v_rsq_f32 v154, v154
    v_mul_f32 v203, v202, v202
    v_mul_f32 v155, v154, v154
    v_fma_f32 v203, v203, v201, s71
    v_fma_f32 v155, v155, v153, s71
    v_rsq_f32 v203, v203
    v_rsq_f32 v155, v155
    v_mul_f32 v202, v202, v203
    v_mul_f32 v154, v154, v155
    v_mul_f32 v203, -v202, v200
    v_mul_f32 v155, -v154, v152
    ds_write_b64 v13, v[202:203] offset:0
    ds_write_b64 v13, v[154:155] offset:256
    s_waitcnt vmcnt(15)
    s_waitcnt lgkmcnt(0)
    s_barrier
    ds_read_b64 v[248:249], v11 offset:0
    ds_read_b128 v[184:187], v2 offset:16384
    ds_read_b128 v[188:191], v2 offset:17408
    ds_read_b128 v[192:195], v2 offset:18432
    ds_read_b64 v[250:251], v11 offset:128
    ds_read_b64 v[252:253], v11 offset:256
    ds_read_b64 v[254:255], v11 offset:384
    s_waitcnt lgkmcnt(6)
    v_pk_fma_f32 v[212:213], v[248:249], v[224:225], v[236:237] op_sel:[1,0,0]
    v_pk_fma_f32 v[214:215], v[248:249], v[226:227], v[238:239] op_sel:[1,0,0]
    v_pk_fma_f32 v[216:217], v[248:249], v[228:229], v[240:241] op_sel:[1,0,0]
    v_pk_fma_f32 v[218:219], v[248:249], v[230:231], v[242:243] op_sel:[1,0,0]
    v_pk_fma_f32 v[220:221], v[248:249], v[232:233], v[244:245] op_sel:[1,0,0]
    v_pk_fma_f32 v[222:223], v[248:249], v[234:235], v[246:247] op_sel:[1,0,0]
    v_pk_fma_f32 v[160:161], v[248:249], v[160:161], v[212:213] op_sel_hi:[0,1,1]
    v_pk_fma_f32 v[162:163], v[248:249], v[162:163], v[214:215] op_sel_hi:[0,1,1]
    v_pk_fma_f32 v[164:165], v[248:249], v[164:165], v[216:217] op_sel_hi:[0,1,1]
    v_pk_fma_f32 v[166:167], v[248:249], v[166:167], v[218:219] op_sel_hi:[0,1,1]
    v_pk_fma_f32 v[168:169], v[248:249], v[168:169], v[220:221] op_sel_hi:[0,1,1]
    v_pk_fma_f32 v[170:171], v[248:249], v[170:171], v[222:223] op_sel_hi:[0,1,1]
    v_pk_mul_f32 v[212:213], v[160:161], v[160:161]
    v_pk_mul_f32 v[214:215], v[162:163], v[162:163]
    v_pk_mul_f32 v[216:217], v[164:165], v[164:165]
    v_pk_mul_f32 v[218:219], v[166:167], v[166:167]
    v_pk_mul_f32 v[220:221], v[168:169], v[168:169]
    v_pk_mul_f32 v[222:223], v[170:171], v[170:171]
    v_pk_fma_f32 v[212:213], v[212:213], s[76:77], v[20:21]
    v_pk_fma_f32 v[214:215], v[214:215], s[76:77], v[20:21]
    v_pk_fma_f32 v[216:217], v[216:217], s[76:77], v[20:21]
    v_pk_fma_f32 v[218:219], v[218:219], s[76:77], v[20:21]
    v_pk_fma_f32 v[220:221], v[220:221], s[76:77], v[20:21]
    v_pk_fma_f32 v[222:223], v[222:223], s[76:77], v[20:21]
    v_pk_mul_f32 v[212:213], v[212:213], v[160:161]
    v_pk_mul_f32 v[214:215], v[214:215], v[162:163]
    v_pk_mul_f32 v[216:217], v[216:217], v[164:165]
    v_pk_mul_f32 v[218:219], v[218:219], v[166:167]
    v_pk_mul_f32 v[220:221], v[220:221], v[168:169]
    v_pk_mul_f32 v[222:223], v[222:223], v[170:171]
    s_waitcnt lgkmcnt(5)
    v_mfma_f32_16x16x32_bf16 v[172:175], a[0:3], v[184:187], 0
    ds_read_b128 v[196:199], v2 offset:19456
    s_waitcnt lgkmcnt(2)
    v_mfma_f32_16x16x32_bf16 v[176:179], a[4:7], v[184:187], 0
    buffer_load_dwordx4 v[84:87], v15, s[12:15], s55 offen offset:0 sc1
    v_mfma_f32_16x16x32_bf16 v[180:183], a[8:11], v[184:187], 0
    v_exp_f32_e64 v212, v212
    v_mfma_f32_16x16x32_bf16 v[172:175], a[12:15], v[188:191], v[172:175]
    ds_read_b128 v[184:187], v2 offset:20480
    s_waitcnt lgkmcnt(2)
    v_mfma_f32_16x16x32_bf16 v[176:179], a[16:19], v[188:191], v[176:179]
    v_exp_f32 v213, v213
    v_mfma_f32_16x16x32_bf16 v[180:183], a[20:23], v[188:191], v[180:183]
    buffer_load_dwordx4 v[88:91], v14, s[12:15], s55 offen offset:2048 sc1
    v_mfma_f32_16x16x32_bf16 v[172:175], a[24:27], v[192:195], v[172:175]
    ds_read_b128 v[188:191], v2 offset:21504
    s_waitcnt lgkmcnt(2)
    v_mfma_f32_16x16x32_bf16 v[176:179], a[28:31], v[192:195], v[176:179]
    v_exp_f32 v214, v214
    v_mfma_f32_16x16x32_bf16 v[180:183], a[32:35], v[192:195], v[180:183]
    v_exp_f32 v215, v215
    v_mfma_f32_16x16x32_bf16 v[172:175], a[36:39], v[196:199], v[172:175]
    ds_read_b128 v[192:195], v2 offset:22528
    s_waitcnt lgkmcnt(2)
    v_mfma_f32_16x16x32_bf16 v[176:179], a[40:43], v[196:199], v[176:179]
    buffer_load_dwordx4 v[92:95], v15, s[12:15], s55 offen offset:2048 sc1
    v_mfma_f32_16x16x32_bf16 v[180:183], a[44:47], v[196:199], v[180:183]
    s_add_u32 s55, s67, 12288
    v_exp_f32_e64 v216, v216
    v_mfma_f32_16x16x32_bf16 v[172:175], a[48:51], v[184:187], v[172:175]
    ds_read_b128 v[196:199], v2 offset:23552
    s_waitcnt lgkmcnt(2)
    v_mfma_f32_16x16x32_bf16 v[176:179], a[52:55], v[184:187], v[176:179]
    v_exp_f32 v217, v217
    v_mfma_f32_16x16x32_bf16 v[180:183], a[56:59], v[184:187], v[180:183]
    buffer_load_dwordx4 v[96:99], v14, s[12:15], s55 offen offset:0 sc1
    v_mfma_f32_16x16x32_bf16 v[172:175], a[60:63], v[188:191], v[172:175]
    ds_read_b128 v[184:187], v2 offset:24576
    s_waitcnt lgkmcnt(2)
    v_mfma_f32_16x16x32_bf16 v[176:179], a[64:67], v[188:191], v[176:179]
    v_exp_f32 v218, v218
    v_mfma_f32_16x16x32_bf16 v[180:183], a[68:71], v[188:191], v[180:183]
    v_exp_f32 v219, v219
    v_mfma_f32_16x16x32_bf16 v[172:175], a[72:75], v[192:195], v[172:175]
    ds_read_b128 v[188:191], v2 offset:25600
    s_waitcnt lgkmcnt(2)
    v_mfma_f32_16x16x32_bf16 v[176:179], a[76:79], v[192:195], v[176:179]
    buffer_load_dwordx4 v[100:103], v15, s[12:15], s55 offen offset:0 sc1
    v_mfma_f32_16x16x32_bf16 v[180:183], a[80:83], v[192:195], v[180:183]
    v_exp_f32 v220, v220
    v_mfma_f32_16x16x32_bf16 v[172:175], a[84:87], v[196:199], v[172:175]
    ds_read_b128 v[192:195], v2 offset:26624
    s_waitcnt lgkmcnt(2)
    v_mfma_f32_16x16x32_bf16 v[176:179], a[88:91], v[196:199], v[176:179]
    v_exp_f32 v221, v221
    v_mfma_f32_16x16x32_bf16 v[180:183], a[92:95], v[196:199], v[180:183]
    buffer_load_dwordx4 v[104:107], v14, s[12:15], s55 offen offset:2048 sc1
    v_mfma_f32_16x16x32_bf16 v[172:175], a[96:99], v[184:187], v[172:175]
    ds_read_b128 v[196:199], v2 offset:27648
    s_waitcnt lgkmcnt(2)
    v_mfma_f32_16x16x32_bf16 v[176:179], a[100:103], v[184:187], v[176:179]
    v_exp_f32 v222, v222
    v_mfma_f32_16x16x32_bf16 v[180:183], a[104:107], v[184:187], v[180:183]
    v_exp_f32 v223, v223
    v_mfma_f32_16x16x32_bf16 v[172:175], a[108:111], v[188:191], v[172:175]
L_hop4:
    s_cbranch_execz L_back1
    ds_read_b128 v[184:187], v2 offset:28672
    s_waitcnt lgkmcnt(2)
    v_mfma_f32_16x16x32_bf16 v[176:179], a[112:115], v[188:191], v[176:179]
    buffer_load_dwordx4 v[108:111], v15, s[12:15], s55 offen offset:2048 sc1
    v_mfma_f32_16x16x32_bf16 v[180:183], a[116:119], v[188:191], v[180:183]
    s_add_u32 s55, s67, 16384
    v_add_f32 v212, 1.0, v212
    v_add_f32 v213, 1.0, v213
    v_mfma_f32_16x16x32_bf16 v[172:175], a[120:123], v[192:195], v[172:175]
    ds_read_b128 v[188:191], v2 offset:29696
    s_waitcnt lgkmcnt(2)
    v_mfma_f32_16x16x32_bf16 v[176:179], a[124:127], v[192:195], v[176:179]
    v_add_f32 v214, 1.0, v214
    v_add_f32 v215, 1.0, v215
    v_mfma_f32_16x16x32_bf16 v[180:183], a[128:131], v[192:195], v[180:183]
    buffer_load_dwordx4 v[112:115], v14, s[12:15], s55 offen offset:0 sc1
    v_mfma_f32_16x16x32_bf16 v[172:175], a[132:135], v[196:199], v[172:175]
    ds_read_b128 v[192:195], v2 offset:30720
    s_waitcnt lgkmcnt(2)
    v_mfma_f32_16x16x32_bf16 v[176:179], a[136:139], v[196:199], v[176:179]
    v_add_f32 v216, 1.0, v216
    v_add_f32 v217, 1.0, v217
    v_mfma_f32_16x16x32_bf16 v[180:183], a[140:143], v[196:199], v[180:183]
    v_add_f32 v218, 1.0, v218
    v_add_f32 v219, 1.0, v219
    v_mfma_f32_16x16x32_bf16 v[172:175], a[144:147], v[184:187], v[172:175]
    ds_read_b128 v[196:199], v2 offset:31744
    s_waitcnt lgkmcnt(2)
    v_mfma_f32_16x16x32_bf16 v[176:179], a[148:151], v[184:187], v[176:179]
    s_waitcnt vmcnt(19)
    s_barrier
    v_add_f32 v220, 1.0, v220
    v_mfma_f32_16x16x32_bf16 v[180:183], a[152:155], v[184:187], v[180:183]
    buffer_load_dwordx4 v[116:119], v15, s[12:15], s55 offen offset:0 sc1
    v_mfma_f32_16x16x32_bf16 v[172:175], a[156:159], v[188:191], v[172:175]
    ds_read_b128 v[184:187], v2 offset:32768
    s_waitcnt lgkmcnt(2)
    v_mfma_f32_16x16x32_bf16 v[176:179], a[160:163], v[188:191], v[176:179]
    v_add_f32 v221, 1.0, v221
    v_add_f32 v222, 1.0, v222
    v_mfma_f32_16x16x32_bf16 v[180:183], a[164:167], v[188:191], v[180:183]
    v_add_f32 v223, 1.0, v223
    v_mfma_f32_16x16x32_bf16 v[172:175], a[168:171], v[192:195], v[172:175]
    ds_read_b128 v[188:191], v2 offset:33792
    s_waitcnt lgkmcnt(2)
    v_mfma_f32_16x16x32_bf16 v[176:179], a[172:175], v[192:195], v[176:179]
    buffer_load_dwordx4 v[120:123], v14, s[12:15], s55 offen offset:2048 sc1
    v_mfma_f32_16x16x32_bf16 v[180:183], a[176:179], v[192:195], v[180:183]
    v_rcp_f32 v212, v212
    v_mfma_f32_16x16x32_bf16 v[172:175], a[180:183], v[196:199], v[172:175]
    ds_read_b128 v[192:195], v2 offset:34816
    s_waitcnt lgkmcnt(2)
    v_mfma_f32_16x16x32_bf16 v[176:179], a[184:187], v[196:199], v[176:179]
    v_rcp_f32 v213, v213
    v_mfma_f32_16x16x32_bf16 v[180:183], a[188:191], v[196:199], v[180:183]
    buffer_load_dwordx4 v[124:127], v15, s[12:15], s55 offen offset:2048 sc1
    v_rcp_f32 v214, v214
    v_rcp_f32 v215, v215
    v_rcp_f32 v216, v216
    v_rcp_f32 v217, v217
    v_rcp_f32 v218, v218
    v_rcp_f32 v219, v219
    v_rcp_f32 v220, v220
    v_rcp_f32 v221, v221
    v_rcp_f32 v222, v222
    v_rcp_f32 v223, v223
    v_pk_mul_f32 v[160:161], v[160:161], v[212:213]
    v_pk_mul_f32 v[162:163], v[162:163], v[214:215]
    v_pk_mul_f32 v[164:165], v[164:165], v[216:217]
    v_pk_mul_f32 v[166:167], v[166:167], v[218:219]
    v_pk_mul_f32 v[168:169], v[168:169], v[220:221]
    v_pk_mul_f32 v[170:171], v[170:171], v[222:223]
    v_cvt_pk_bf16_f32 v200, v160, v161
    v_cvt_pk_bf16_f32 v201, v162, v163
    v_cvt_pk_bf16_f32 v204, v164, v165
    v_cvt_pk_bf16_f32 v205, v166, v167
    v_cvt_pk_bf16_f32 v208, v168, v169
    v_cvt_pk_bf16_f32 v209, v170, v171
    s_add_u32 s55, s67, 20480
    buffer_load_dwordx4 v[128:131], v14, s[12:15], s55 offen offset:0 sc1
    v_pk_fma_f32 v[212:213], v[250:251], v[224:225], v[236:237] op_sel:[1,0,0]
    v_pk_fma_f32 v[214:215], v[250:251], v[226:227], v[238:239] op_sel:[1,0,0]
    v_pk_fma_f32 v[216:217], v[250:251], v[228:229], v[240:241] op_sel:[1,0,0]
    v_pk_fma_f32 v[218:219], v[250:251], v[230:231], v[242:243] op_sel:[1,0,0]
    v_pk_fma_f32 v[220:221], v[250:251], v[232:233], v[244:245] op_sel:[1,0,0]
    v_pk_fma_f32 v[222:223], v[250:251], v[234:235], v[246:247] op_sel:[1,0,0]
    v_pk_fma_f32 v[172:173], v[250:251], v[172:173], v[212:213] op_sel_hi:[0,1,1]
    v_pk_fma_f32 v[174:175], v[250:251], v[174:175], v[214:215] op_sel_hi:[0,1,1]
    v_pk_fma_f32 v[176:177], v[250:251], v[176:177], v[216:217] op_sel_hi:[0,1,1]
    v_pk_fma_f32 v[178:179], v[250:251], v[178:179], v[218:219] op_sel_hi:[0,1,1]
    v_pk_fma_f32 v[180:181], v[250:251], v[180:181], v[220:221] op_sel_hi:[0,1,1]
    v_pk_fma_f32 v[182:183], v[250:251], v[182:183], v[222:223] op_sel_hi:[0,1,1]
    v_pk_mul_f32 v[212:213], v[172:173], v[172:173]
    v_pk_mul_f32 v[214:215], v[174:175], v[174:175]
    v_pk_mul_f32 v[216:217], v[176:177], v[176:177]
    v_pk_mul_f32 v[218:219], v[178:179], v[178:179]
    v_pk_mul_f32 v[220:221], v[180:181], v[180:181]
    v_pk_mul_f32 v[222:223], v[182:183], v[182:183]
    v_pk_fma_f32 v[212:213], v[212:213], s[76:77], v[20:21]
    v_pk_fma_f32 v[214:215], v[214:215], s[76:77], v[20:21]
    v_pk_fma_f32 v[216:217], v[216:217], s[76:77], v[20:21]
    v_pk_fma_f32 v[218:219], v[218:219], s[76:77], v[20:21]
    v_pk_fma_f32 v[220:221], v[220:221], s[76:77], v[20:21]
    v_pk_fma_f32 v[222:223], v[222:223], s[76:77], v[20:21]
    v_pk_mul_f32 v[212:213], v[212:213], v[172:173]
    v_pk_mul_f32 v[214:215], v[214:215], v[174:175]
    v_pk_mul_f32 v[216:217], v[216:217], v[176:177]
    v_pk_mul_f32 v[218:219], v[218:219], v[178:179]
    v_pk_mul_f32 v[220:221], v[220:221], v[180:181]
    v_pk_mul_f32 v[222:223], v[222:223], v[182:183]
    buffer_load_dwordx4 v[132:135], v15, s[12:15], s55 offen offset:0 sc1
    v_exp_f32 v212, v212
    v_exp_f32 v213, v213
    v_exp_f32 v214, v214
    v_exp_f32 v215, v215
    v_exp_f32 v216, v216
    v_exp_f32 v217, v217
    v_exp_f32 v218, v218
    v_exp_f32 v219, v219
    v_exp_f32 v220, v220
    v_exp_f32 v221, v221
    v_exp_f32 v222, v222
    v_exp_f32 v223, v223
    v_pk_add_f32 v[212:213], v[212:213], 1.0 op_sel_hi:[1,0]
    v_pk_add_f32 v[214:215], v[214:215], 1.0 op_sel_hi:[1,0]
    v_pk_add_f32 v[216:217], v[216:217], 1.0 op_sel_hi:[1,0]
    v_pk_add_f32 v[218:219], v[218:219], 1.0 op_sel_hi:[1,0]
    v_pk_add_f32 v[220:221], v[220:221], 1.0 op_sel_hi:[1,0]
    v_pk_add_f32 v[222:223], v[222:223], 1.0 op_sel_hi:[1,0]
    v_rcp_f32 v212, v212
    v_rcp_f32 v213, v213
    v_rcp_f32 v214, v214
    v_rcp_f32 v215, v215
    v_rcp_f32 v216, v216
    v_rcp_f32 v217, v217
    v_rcp_f32 v218, v218
    v_rcp_f32 v219, v219
    v_rcp_f32 v220, v220
    v_rcp_f32 v221, v221
    v_rcp_f32 v222, v222
    v_rcp_f32 v223, v223
    v_pk_mul_f32 v[172:173], v[172:173], v[212:213]
    v_pk_mul_f32 v[174:175], v[174:175], v[214:215]
    v_pk_mul_f32 v[176:177], v[176:177], v[216:217]
    v_pk_mul_f32 v[178:179], v[178:179], v[218:219]
    v_pk_mul_f32 v[180:181], v[180:181], v[220:221]
    v_pk_mul_f32 v[182:183], v[182:183], v[222:223]
    v_cvt_pk_bf16_f32 v202, v172, v173
    v_cvt_pk_bf16_f32 v203, v174, v175
    v_cvt_pk_bf16_f32 v206, v176, v177
    v_cvt_pk_bf16_f32 v207, v178, v179
    v_cvt_pk_bf16_f32 v210, v180, v181
    v_cvt_pk_bf16_f32 v211, v182, v183
    v_permlane16_swap_b32 v200, v202
    v_permlane16_swap_b32 v201, v203
    v_permlane16_swap_b32 v204, v206
    v_permlane16_swap_b32 v205, v207
    v_permlane16_swap_b32 v208, v210
    v_permlane16_swap_b32 v209, v211
    buffer_store_dwordx4 v[200:203], v2, s[12:15], s65 offen offset:0 sc1
    buffer_store_dwordx4 v[204:207], v2, s[12:15], s53 offen offset:1024 sc1
    buffer_store_dwordx4 v[208:211], v2, s[12:15], s53 offen offset:2048 sc1
    v_mfma_f32_16x16x32_bf16 v[160:163], a[0:3], v[184:187], 0
    ds_read_b128 v[196:199], v2 offset:35840
    s_waitcnt lgkmcnt(2)
    v_mfma_f32_16x16x32_bf16 v[164:167], a[4:7], v[184:187], 0
    v_mfma_f32_16x16x32_bf16 v[168:171], a[8:11], v[184:187], 0
    v_mfma_f32_16x16x32_bf16 v[160:163], a[12:15], v[188:191], v[160:163]
    ds_read_b128 v[184:187], v2 offset:36864
    s_waitcnt lgkmcnt(2)
    v_mfma_f32_16x16x32_bf16 v[164:167], a[16:19], v[188:191], v[164:167]
    v_mfma_f32_16x16x32_bf16 v[168:171], a[20:23], v[188:191], v[168:171]
    v_mfma_f32_16x16x32_bf16 v[160:163], a[24:27], v[192:195], v[160:163]
    ds_read_b128 v[188:191], v2 offset:37888
    s_waitcnt lgkmcnt(2)
    v_mfma_f32_16x16x32_bf16 v[164:167], a[28:31], v[192:195], v[164:167]
    v_mfma_f32_16x16x32_bf16 v[168:171], a[32:35], v[192:195], v[168:171]
    v_mfma_f32_16x16x32_bf16 v[160:163], a[36:39], v[196:199], v[160:163]
    ds_read_b128 v[192:195], v2 offset:38912
    s_waitcnt lgkmcnt(2)
    v_mfma_f32_16x16x32_bf16 v[164:167], a[40:43], v[196:199], v[164:167]
    v_mfma_f32_16x16x32_bf16 v[168:171], a[44:47], v[196:199], v[168:171]
    v_mfma_f32_16x16x32_bf16 v[160:163], a[48:51], v[184:187], v[160:163]
    ds_read_b128 v[196:199], v2 offset:39936
    s_waitcnt lgkmcnt(2)
    v_mfma_f32_16x16x32_bf16 v[164:167], a[52:55], v[184:187], v[164:167]
    v_mfma_f32_16x16x32_bf16 v[168:171], a[56:59], v[184:187], v[168:171]
    v_mfma_f32_16x16x32_bf16 v[160:163], a[60:63], v[188:191], v[160:163]
    ds_read_b128 v[184:187], v2 offset:40960
    s_waitcnt lgkmcnt(2)
    v_mfma_f32_16x16x32_bf16 v[164:167], a[64:67], v[188:191], v[164:167]
    v_mfma_f32_16x16x32_bf16 v[168:171], a[68:71], v[188:191], v[168:171]
    v_mfma_f32_16x16x32_bf16 v[160:163], a[72:75], v[192:195], v[160:163]
    ds_read_b128 v[188:191], v2 offset:41984
    s_waitcnt lgkmcnt(2)
    v_mfma_f32_16x16x32_bf16 v[164:167], a[76:79], v[192:195], v[164:167]
    v_mfma_f32_16x16x32_bf16 v[168:171], a[80:83], v[192:195], v[168:171]
    v_mfma_f32_16x16x32_bf16 v[160:163], a[84:87], v[196:199], v[160:163]
    ds_read_b128 v[192:195], v2 offset:43008
    s_waitcnt lgkmcnt(2)
    v_mfma_f32_16x16x32_bf16 v[164:167], a[88:91], v[196:199], v[164:167]
    v_mfma_f32_16x16x32_bf16 v[168:171], a[92:95], v[196:199], v[168:171]
    v_mfma_f32_16x16x32_bf16 v[160:163], a[96:99], v[184:187], v[160:163]
    ds_read_b128 v[196:199], v2 offset:44032
    s_waitcnt lgkmcnt(2)
    v_mfma_f32_16x16x32_bf16 v[164:167], a[100:103], v[184:187], v[164:167]
    v_mfma_f32_16x16x32_bf16 v[168:171], a[104:107], v[184:187], v[168:171]
    buffer_load_dwordx4 v[136:139], v14, s[12:15], s55 offen offset:2048 sc1
    v_mfma_f32_16x16x32_bf16 v[160:163], a[108:111], v[188:191], v[160:163]
    ds_read_b128 v[184:187], v2 offset:45056
    s_waitcnt lgkmcnt(2)
    v_mfma_f32_16x16x32_bf16 v[164:167], a[112:115], v[188:191], v[164:167]
    v_mfma_f32_16x16x32_bf16 v[168:171], a[116:119], v[188:191], v[168:171]
    v_mfma_f32_16x16x32_bf16 v[160:163], a[120:123], v[192:195], v[160:163]
    ds_read_b128 v[188:191], v2 offset:46080
    s_waitcnt lgkmcnt(2)
    v_mfma_f32_16x16x32_bf16 v[164:167], a[124:127], v[192:195], v[164:167]
    buffer_load_dwordx4 v[140:143], v15, s[12:15], s55 offen offset:2048 sc1
    v_mfma_f32_16x16x32_bf16 v[168:171], a[128:131], v[192:195], v[168:171]
    s_add_u32 s55, s67, 24576
    v_mfma_f32_16x16x32_bf16 v[160:163], a[132:135], v[196:199], v[160:163]
    ds_read_b128 v[192:195], v2 offset:47104
    s_waitcnt lgkmcnt(2)
    v_mfma_f32_16x16x32_bf16 v[164:167], a[136:139], v[196:199], v[164:167]
    v_mfma_f32_16x16x32_bf16 v[168:171], a[140:143], v[196:199], v[168:171]
    buffer_load_dwordx4 v[144:147], v14, s[12:15], s55 offen offset:0 sc1
    v_mfma_f32_16x16x32_bf16 v[160:163], a[144:147], v[184:187], v[160:163]
    ds_read_b128 v[196:199], v2 offset:48128
    s_waitcnt lgkmcnt(2)
    v_mfma_f32_16x16x32_bf16 v[164:167], a[148:151], v[184:187], v[164:167]
    s_waitcnt vmcnt(26)
    s_barrier
    v_mfma_f32_16x16x32_bf16 v[168:171], a[152:155], v[184:187], v[168:171]
    v_mfma_f32_16x16x32_bf16 v[160:163], a[156:159], v[188:191], v[160:163]
    ds_read_b128 v[184:187], v2 offset:49152
    s_waitcnt lgkmcnt(2)
    v_mfma_f32_16x16x32_bf16 v[164:167], a[160:163], v[188:191], v[164:167]
    buffer_load_dwordx4 v[148:151], v15, s[12:15], s55 offen offset:0 sc1
    v_mfma_f32_16x16x32_bf16 v[168:171], a[164:167], v[188:191], v[168:171]
    v_mfma_f32_16x16x32_bf16 v[160:163], a[168:171], v[192:195], v[160:163]
    ds_read_b128 v[188:191], v2 offset:50176
    s_waitcnt lgkmcnt(2)
    v_mfma_f32_16x16x32_bf16 v[164:167], a[172:175], v[192:195], v[164:167]
    v_mfma_f32_16x16x32_bf16 v[168:171], a[176:179], v[192:195], v[168:171]
    buffer_load_dwordx4 v[152:155], v14, s[12:15], s55 offen offset:2048 sc1
    v_mfma_f32_16x16x32_bf16 v[160:163], a[180:183], v[196:199], v[160:163]
    ds_read_b128 v[192:195], v2 offset:51200
    s_waitcnt lgkmcnt(2)
    v_mfma_f32_16x16x32_bf16 v[164:167], a[184:187], v[196:199], v[164:167]
    v_mfma_f32_16x16x32_bf16 v[168:171], a[188:191], v[196:199], v[168:171]
    v_pk_fma_f32 v[212:213], v[252:253], v[224:225], v[236:237] op_sel:[1,0,0]
    v_pk_fma_f32 v[214:215], v[252:253], v[226:227], v[238:239] op_sel:[1,0,0]
    v_pk_fma_f32 v[216:217], v[252:253], v[228:229], v[240:241] op_sel:[1,0,0]
    v_pk_fma_f32 v[218:219], v[252:253], v[230:231], v[242:243] op_sel:[1,0,0]
    v_pk_fma_f32 v[220:221], v[252:253], v[232:233], v[244:245] op_sel:[1,0,0]
    v_pk_fma_f32 v[222:223], v[252:253], v[234:235], v[246:247] op_sel:[1,0,0]
    v_pk_fma_f32 v[160:161], v[252:253], v[160:161], v[212:213] op_sel_hi:[0,1,1]
    v_pk_fma_f32 v[162:163], v[252:253], v[162:163], v[214:215] op_sel_hi:[0,1,1]
    v_pk_fma_f32 v[164:165], v[252:253], v[164:165], v[216:217] op_sel_hi:[0,1,1]
    v_pk_fma_f32 v[166:167], v[252:253], v[166:167], v[218:219] op_sel_hi:[0,1,1]
    v_pk_fma_f32 v[168:169], v[252:253], v[168:169], v[220:221] op_sel_hi:[0,1,1]
    v_pk_fma_f32 v[170:171], v[252:253], v[170:171], v[222:223] op_sel_hi:[0,1,1]
    v_pk_mul_f32 v[212:213], v[160:161], v[160:161]
    v_pk_mul_f32 v[214:215], v[162:163], v[162:163]
    v_pk_mul_f32 v[216:217], v[164:165], v[164:165]
    v_pk_mul_f32 v[218:219], v[166:167], v[166:167]
    v_pk_mul_f32 v[220:221], v[168:169], v[168:169]
    v_pk_mul_f32 v[222:223], v[170:171], v[170:171]
    v_pk_fma_f32 v[212:213], v[212:213], s[76:77], v[20:21]
    v_pk_fma_f32 v[214:215], v[214:215], s[76:77], v[20:21]
    v_pk_fma_f32 v[216:217], v[216:217], s[76:77], v[20:21]
    v_pk_fma_f32 v[218:219], v[218:219], s[76:77], v[20:21]
    v_pk_fma_f32 v[220:221], v[220:221], s[76:77], v[20:21]
    v_pk_fma_f32 v[222:223], v[222:223], s[76:77], v[20:21]
    v_pk_mul_f32 v[212:213], v[212:213], v[160:161]
    v_pk_mul_f32 v[214:215], v[214:215], v[162:163]
    v_pk_mul_f32 v[216:217], v[216:217], v[164:165]
    v_pk_mul_f32 v[218:219], v[218:219], v[166:167]
    v_pk_mul_f32 v[220:221], v[220:221], v[168:169]
    v_pk_mul_f32 v[222:223], v[222:223], v[170:171]
    s_waitcnt vmcnt(5)
    s_barrier
    s_cmp_lg_u32 s47, 3
    s_cbranch_scc1 L_nf5
    s_cmp_eq_u32 s72, 0
    s_cbranch_scc1 L_ff5
    buffer_store_dword v22, v23, s[12:15], s80 offen offset:2048
    s_branch L_nf5
L_ff5:
    buffer_store_dword v22, v23, s[12:15], s80 offen offset:2048 sc1
L_nf5:
    v_mfma_f32_16x16x32_bf16 v[172:175], a[0:3], v[184:187], 0
    ds_read_b128 v[196:199], v2 offset:52224
    s_waitcnt lgkmcnt(2)
    v_mfma_f32_16x16x32_bf16 v[176:179], a[4:7], v[184:187], 0
    buffer_load_dwordx4 v[156:159], v15, s[12:15], s55 offen offset:2048 sc1
    v_mfma_f32_16x16x32_bf16 v[180:183], a[8:11], v[184:187], 0
    s_add_u32 s55, s67, 36864
    v_exp_f32 v212, v212
    v_mfma_f32_16x16x32_bf16 v[172:175], a[12:15], v[188:191], v[172:175]
    ds_read_b128 v[184:187], v2 offset:53248
    s_waitcnt lgkmcnt(2)
    v_mfma_f32_16x16x32_bf16 v[176:179], a[16:19], v[188:191], v[176:179]
    v_exp_f32 v213, v213
    v_mfma_f32_16x16x32_bf16 v[180:183], a[20:23], v[188:191], v[180:183]
    buffer_load_dwordx4 a[224:227], v14, s[12:15], s55 offen offset:0 sc1
    v_mfma_f32_16x16x32_bf16 v[172:175], a[24:27], v[192:195], v[172:175]
    ds_read_b128 v[188:191], v2 offset:54272
    s_waitcnt lgkmcnt(2)
    v_mfma_f32_16x16x32_bf16 v[176:179], a[28:31], v[192:195], v[176:179]
    v_exp_f32 v214, v214
    v_mfma_f32_16x16x32_bf16 v[180:183], a[32:35], v[192:195], v[180:183]
    v_exp_f32 v215, v215
    v_mfma_f32_16x16x32_bf16 v[172:175], a[36:39], v[196:199], v[172:175]
    ds_read_b128 v[192:195], v2 offset:55296
    s_waitcnt lgkmcnt(2)
    v_mfma_f32_16x16x32_bf16 v[176:179], a[40:43], v[196:199], v[176:179]
    buffer_load_dwordx4 a[228:231], v15, s[12:15], s55 offen offset:0 sc1
    v_mfma_f32_16x16x32_bf16 v[180:183], a[44:47], v[196:199], v[180:183]
    v_exp_f32 v216, v216
    v_mfma_f32_16x16x32_bf16 v[172:175], a[48:51], v[184:187], v[172:175]
    ds_read_b128 v[196:199], v2 offset:56320
    s_waitcnt lgkmcnt(2)
    v_mfma_f32_16x16x32_bf16 v[176:179], a[52:55], v[184:187], v[176:179]
    v_exp_f32 v217, v217
    v_mfma_f32_16x16x32_bf16 v[180:183], a[56:59], v[184:187], v[180:183]
    buffer_load_dwordx4 a[232:235], v14, s[12:15], s55 offen offset:2048 sc1
    v_mfma_f32_16x16x32_bf16 v[172:175], a[60:63], v[188:191], v[172:175]
    ds_read_b128 v[184:187], v2 offset:57344
    s_waitcnt lgkmcnt(2)
    v_mfma_f32_16x16x32_bf16 v[176:179], a[64:67], v[188:191], v[176:179]
    v_exp_f32 v218, v218
    v_mfma_f32_16x16x32_bf16 v[180:183], a[68:71], v[188:191], v[180:183]
    v_exp_f32 v219, v219
    v_mfma_f32_16x16x32_bf16 v[172:175], a[72:75], v[192:195], v[172:175]
    ds_read_b128 v[188:191], v2 offset:58368
    s_waitcnt lgkmcnt(2)
    v_mfma_f32_16x16x32_bf16 v[176:179], a[76:79], v[192:195], v[176:179]
    v_exp_f32 v220, v220
    v_mfma_f32_16x16x32_bf16 v[180:183], a[80:83], v[192:195], v[180:183]
    v_exp_f32 v221, v221
    v_mfma_f32_16x16x32_bf16 v[172:175], a[84:87], v[196:199], v[172:175]
    ds_read_b128 v[192:195], v2 offset:59392
    s_waitcnt lgkmcnt(2)
    v_mfma_f32_16x16x32_bf16 v[176:179], a[88:91], v[196:199], v[176:179]
    v_exp_f32 v222, v222
    v_mfma_f32_16x16x32_bf16 v[180:183], a[92:95], v[196:199], v[180:183]
    v_exp_f32 v223, v223
    v_mfma_f32_16x16x32_bf16 v[172:175], a[96:99], v[184:187], v[172:175]
    ds_read_b128 v[196:199], v2 offset:60416
    s_waitcnt lgkmcnt(2)
    v_mfma_f32_16x16x32_bf16 v[176:179], a[100:103], v[184:187], v[176:179]
    v_add_f32 v212, 1.0, v212
    v_add_f32 v213, 1.0, v213
    v_mfma_f32_16x16x32_bf16 v[180:183], a[104:107], v[184:187], v[180:183]
    buffer_load_dword v4, v10, s[12:15], s66 offen offset:2048 sc1
    v_mfma_f32_16x16x32_bf16 v[172:175], a[108:111], v[188:191], v[172:175]
    ds_read_b128 v[184:187], v2 offset:61440
    s_waitcnt lgkmcnt(2)
    v_mfma_f32_16x16x32_bf16 v[176:179], a[112:115], v[188:191], v[176:179]
    v_add_f32 v214, 1.0, v214
    v_add_f32 v215, 1.0, v215
    v_mfma_f32_16x16x32_bf16 v[180:183], a[116:119], v[188:191], v[180:183]
    v_add_f32 v216, 1.0, v216
    v_add_f32 v217, 1.0, v217
    v_mfma_f32_16x16x32_bf16 v[172:175], a[120:123], v[192:195], v[172:175]
    ds_read_b128 v[188:191], v2 offset:62464
    s_waitcnt lgkmcnt(2)
    v_mfma_f32_16x16x32_bf16 v[176:179], a[124:127], v[192:195], v[176:179]
    buffer_load_dwordx4 a[236:239], v15, s[12:15], s55 offen offset:2048 sc1
    v_mfma_f32_16x16x32_bf16 v[180:183], a[128:131], v[192:195], v[180:183]
    s_add_u32 s55, s67, 40960
    v_add_f32 v218, 1.0, v218
    v_add_f32 v219, 1.0, v219
    v_mfma_f32_16x16x32_bf16 v[172:175], a[132:135], v[196:199], v[172:175]
    ds_read_b128 v[192:195], v2 offset:63488
    s_waitcnt lgkmcnt(2)
    v_mfma_f32_16x16x32_bf16 v[176:179], a[136:139], v[196:199], v[176:179]
    v_add_f32 v220, 1.0, v220
    v_add_f32_e64 v221, 1.0, v221
    v_mfma_f32_16x16x32_bf16 v[180:183], a[140:143], v[196:199], v[180:183]
    buffer_load_dwordx4 a[240:243], v14, s[12:15], s55 offen offset:0 sc1
    v_mfma_f32_16x16x32_bf16 v[172:175], a[144:147], v[184:187], v[172:175]
    ds_read_b128 v[196:199], v2 offset:64512
    s_waitcnt lgkmcnt(2)
    v_mfma_f32_16x16x32_bf16 v[176:179], a[148:151], v[184:187], v[176:179]
    v_add_f32 v222, 1.0, v222
    v_add_f32 v223, 1.0, v223
    v_mfma_f32_16x16x32_bf16 v[180:183], a[152:155], v[184:187], v[180:183]
    v_rcp_f32 v212, v212
    v_mfma_f32_16x16x32_bf16 v[172:175], a[156:159], v[188:191], v[172:175]
    buffer_load_dwordx4 a[244:247], v15, s[12:15], s55 offen offset:0 sc1
    v_mfma_f32_16x16x32_bf16 v[176:179], a[160:163], v[188:191], v[176:179]
    v_rcp_f32 v213, v213
    v_mfma_f32_16x16x32_bf16 v[180:183], a[164:167], v[188:191], v[180:183]
    v_rcp_f32 v214, v214
    s_waitcnt lgkmcnt(1)
    v_mfma_f32_16x16x32_bf16 v[172:175], a[168:171], v[192:195], v[172:175]
    v_rcp_f32 v215, v215
    v_mfma_f32_16x16x32_bf16 v[176:179], a[172:175], v[192:195], v[176:179]
    buffer_load_dwordx4 a[248:251], v14, s[12:15], s55 offen offset:2048 sc1
    v_mfma_f32_16x16x32_bf16 v[180:183], a[176:179], v[192:195], v[180:183]
    v_rcp_f32 v216, v216
    s_waitcnt lgkmcnt(0)
    v_mfma_f32_16x16x32_bf16 v[172:175], a[180:183], v[196:199], v[172:175]
    v_rcp_f32 v217, v217
    v_mfma_f32_16x16x32_bf16 v[176:179], a[184:187], v[196:199], v[176:179]
    v_rcp_f32 v218, v218
    v_mfma_f32_16x16x32_bf16 v[180:183], a[188:191], v[196:199], v[180:183]
    buffer_load_dwordx4 a[252:255], v15, s[12:15], s55 offen offset:2048 sc1
    v_rcp_f32 v219, v219
    v_rcp_f32 v220, v220
    v_rcp_f32 v221, v221
    v_rcp_f32 v222, v222
    v_rcp_f32 v223, v223
    s_waitcnt vmcnt(5)
    v_cmp_ne_u32 vcc, 0, v4
    s_nop 1
    s_cmp_eq_u32 vcc_lo, 255
    s_cbranch_scc1 L_ok6
    s_mov_b32 s45, 0
L_spin6:
    buffer_load_dword v4, v10, s[12:15], s66 offen offset:2048 sc1
    s_add_u32 s45, s45, 1
    s_waitcnt vmcnt(0)
    v_cmp_ne_u32 vcc, 0, v4
    s_cmp_ge_u32 s45, 262144
    s_cbranch_scc1 L_ok6
    s_nop 1
    s_nop 1
    s_cmp_eq_u32 vcc_lo, 255
    s_cbranch_scc0 L_spin6
L_ok6:
    s_add_u32 s7, s6, 0
    buffer_load_dwordx4 a[0:3], v2, s[12:15], s7 offen offset:0 sc1
    v_pk_mul_f32 v[160:161], v[160:161], v[212:213]
    v_pk_mul_f32 v[162:163], v[162:163], v[214:215]
    v_pk_mul_f32 v[164:165], v[164:165], v[216:217]
    v_pk_mul_f32 v[166:167], v[166:167], v[218:219]
    buffer_load_dwordx4 a[4:7], v2, s[12:15], s7 offen offset:1024 sc1
    v_pk_mul_f32 v[168:169], v[168:169], v[220:221]
    v_pk_mul_f32 v[170:171], v[170:171], v[222:223]
    v_cvt_pk_bf16_f32 v200, v160, v161
    v_cvt_pk_bf16_f32 v201, v162, v163
    buffer_load_dwordx4 a[8:11], v2, s[12:15], s7 offen offset:2048 sc1
    v_cvt_pk_bf16_f32 v204, v164, v165
    v_cvt_pk_bf16_f32 v205, v166, v167
    v_cvt_pk_bf16_f32 v208, v168, v169
    v_cvt_pk_bf16_f32 v209, v170, v171
    buffer_load_dwordx4 a[12:15], v2, s[12:15], s7 offen offset:3072 sc1
    v_pk_fma_f32 v[212:213], v[254:255], v[224:225], v[236:237] op_sel:[1,0,0]
    v_pk_fma_f32 v[214:215], v[254:255], v[226:227], v[238:239] op_sel:[1,0,0]
    v_pk_fma_f32 v[216:217], v[254:255], v[228:229], v[240:241] op_sel:[1,0,0]
    v_pk_fma_f32 v[218:219], v[254:255], v[230:231], v[242:243] op_sel:[1,0,0]
    s_add_u32 s7, s6, 4096
    buffer_load_dwordx4 a[16:19], v2, s[12:15], s7 offen offset:0 sc1
    v_pk_fma_f32 v[220:221], v[254:255], v[232:233], v[244:245] op_sel:[1,0,0]
    v_pk_fma_f32 v[222:223], v[254:255], v[234:235], v[246:247] op_sel:[1,0,0]
    v_pk_fma_f32 v[172:173], v[254:255], v[172:173], v[212:213] op_sel_hi:[0,1,1]
    v_pk_fma_f32 v[174:175], v[254:255], v[174:175], v[214:215] op_sel_hi:[0,1,1]
    buffer_load_dwordx4 a[20:23], v2, s[12:15], s7 offen offset:1024 sc1
    v_pk_fma_f32 v[176:177], v[254:255], v[176:177], v[216:217] op_sel_hi:[0,1,1]
    v_pk_fma_f32 v[178:179], v[254:255], v[178:179], v[218:219] op_sel_hi:[0,1,1]
    v_pk_fma_f32 v[180:181], v[254:255], v[180:181], v[220:221] op_sel_hi:[0,1,1]
    v_pk_fma_f32 v[182:183], v[254:255], v[182:183], v[222:223] op_sel_hi:[0,1,1]
    buffer_load_dwordx4 a[24:27], v2, s[12:15], s7 offen offset:2048 sc1
    v_pk_mul_f32 v[212:213], v[172:173], v[172:173]
    v_pk_mul_f32 v[214:215], v[174:175], v[174:175]
    v_pk_mul_f32 v[216:217], v[176:177], v[176:177]
    v_pk_mul_f32 v[218:219], v[178:179], v[178:179]
    buffer_load_dwordx4 a[28:31], v2, s[12:15], s7 offen offset:3072 sc1
    v_pk_mul_f32 v[220:221], v[180:181], v[180:181]
    v_pk_mul_f32 v[222:223], v[182:183], v[182:183]
    v_pk_fma_f32 v[212:213], v[212:213], s[76:77], v[20:21]
    v_pk_fma_f32 v[214:215], v[214:215], s[76:77], v[20:21]
    s_add_u32 s7, s6, 8192
    buffer_load_dwordx4 a[32:35], v2, s[12:15], s7 offen offset:0 sc1
    v_pk_fma_f32 v[216:217], v[216:217], s[76:77], v[20:21]
    v_pk_fma_f32 v[218:219], v[218:219], s[76:77], v[20:21]
    v_pk_fma_f32 v[220:221], v[220:221], s[76:77], v[20:21]
    v_pk_fma_f32 v[222:223], v[222:223], s[76:77], v[20:21]
    buffer_load_dwordx4 a[36:39], v2, s[12:15], s7 offen offset:1024 sc1
    v_pk_mul_f32 v[212:213], v[212:213], v[172:173]
    v_pk_mul_f32 v[214:215], v[214:215], v[174:175]
    v_pk_mul_f32 v[216:217], v[216:217], v[176:177]
    v_pk_mul_f32 v[218:219], v[218:219], v[178:179]
    buffer_load_dwordx4 a[40:43], v2, s[12:15], s7 offen offset:2048 sc1
    v_pk_mul_f32 v[220:221], v[220:221], v[180:181]
    v_pk_mul_f32 v[222:223], v[222:223], v[182:183]
    v_exp_f32 v212, v212
    v_exp_f32 v213, v213
    buffer_load_dwordx4 a[44:47], v2, s[12:15], s7 offen offset:3072 sc1
    v_exp_f32 v214, v214
    v_exp_f32 v215, v215
    v_exp_f32 v216, v216
    v_exp_f32 v217, v217
    s_add_u32 s7, s6, 12288
    buffer_load_dwordx4 a[48:51], v2, s[12:15], s7 offen offset:0 sc1
    v_exp_f32 v218, v218
    v_exp_f32 v219, v219
    v_exp_f32 v220, v220
    v_exp_f32 v221, v221
    buffer_load_dwordx4 a[52:55], v2, s[12:15], s7 offen offset:1024 sc1
    v_exp_f32 v222, v222
    v_exp_f32 v223, v223
    v_pk_add_f32 v[212:213], v[212:213], 1.0 op_sel_hi:[1,0]
    v_pk_add_f32 v[214:215], v[214:215], 1.0 op_sel_hi:[1,0]
    buffer_load_dwordx4 a[56:59], v2, s[12:15], s7 offen offset:2048 sc1
    v_pk_add_f32 v[216:217], v[216:217], 1.0 op_sel_hi:[1,0]
    v_pk_add_f32 v[218:219], v[218:219], 1.0 op_sel_hi:[1,0]
    v_pk_add_f32 v[220:221], v[220:221], 1.0 op_sel_hi:[1,0]
    v_pk_add_f32 v[222:223], v[222:223], 1.0 op_sel_hi:[1,0]
    buffer_load_dwordx4 a[60:63], v2, s[12:15], s7 offen offset:3072 sc1
    v_rcp_f32 v212, v212
    v_rcp_f32 v213, v213
    v_rcp_f32 v214, v214
    v_rcp_f32 v215, v215
    v_rcp_f32 v216, v216
    v_rcp_f32 v217, v217
    v_rcp_f32 v218, v218
    v_rcp_f32 v219, v219
    v_rcp_f32 v220, v220
    v_rcp_f32 v221, v221
    v_rcp_f32 v222, v222
    v_rcp_f32 v223, v223
    v_pk_mul_f32 v[172:173], v[172:173], v[212:213]
    v_pk_mul_f32 v[174:175], v[174:175], v[214:215]
    v_pk_mul_f32 v[176:177], v[176:177], v[216:217]
    v_pk_mul_f32 v[178:179], v[178:179], v[218:219]
    v_pk_mul_f32 v[180:181], v[180:181], v[220:221]
    v_pk_mul_f32 v[182:183], v[182:183], v[222:223]
    v_cvt_pk_bf16_f32 v202, v172, v173
    v_cvt_pk_bf16_f32 v203, v174, v175
    v_cvt_pk_bf16_f32 v206, v176, v177
    v_cvt_pk_bf16_f32 v207, v178, v179
    v_cvt_pk_bf16_f32 v210, v180, v181
    v_cvt_pk_bf16_f32 v211, v182, v183
    v_permlane16_swap_b32 v200, v202
    v_permlane16_swap_b32 v201, v203
    v_permlane16_swap_b32 v204, v206
    v_permlane16_swap_b32 v205, v207
    v_permlane16_swap_b32 v208, v210
    v_permlane16_swap_b32 v209, v211
    s_add_u32 s65, s65, 90112
    s_add_u32 s53, s53, 90112
    buffer_store_dwordx4 v[200:203], v2, s[12:15], s65 offen offset:0 sc1
    buffer_store_dwordx4 v[204:207], v2, s[12:15], s53 offen offset:1024 sc1
    buffer_store_dwordx4 v[208:211], v2, s[12:15], s53 offen offset:2048 sc1
    v_and_b32_e64 v12, 31, v1
    v_lshlrev_b32 v12, 10, v12
    v_lshrrev_b32 v13, 5, v1
    v_lshl_add_u32 v12, v13, 4, v12
    s_lshl_b32 s4, s49, 16
    s_lshl_b32 s44, s50, 5
    s_add_u32 s4, s4, s44
    s_waitcnt vmcnt(18)
    v_mfma_f32_32x32x16_bf16 v[160:175], v[48:51], a[0:3], 0
    v_mfma_f32_32x32x16_bf16 v[176:191], v[52:55], a[0:3], 0
    s_waitcnt vmcnt(17)
    v_mfma_f32_32x32x16_bf16 v[160:175], v[56:59], a[4:7], v[160:175]
    v_mfma_f32_32x32x16_bf16 v[176:191], v[60:63], a[4:7], v[176:191]
    s_waitcnt vmcnt(16)
    v_mfma_f32_32x32x16_bf16 v[160:175], v[64:67], a[8:11], v[160:175]
    v_mfma_f32_32x32x16_bf16 v[176:191], v[68:71], a[8:11], v[176:191]
    s_waitcnt vmcnt(15)
    v_mfma_f32_32x32x16_bf16 v[160:175], v[72:75], a[12:15], v[160:175]
    v_mfma_f32_32x32x16_bf16 v[176:191], v[76:79], a[12:15], v[176:191]
    s_waitcnt vmcnt(14)
    v_mfma_f32_32x32x16_bf16 v[160:175], v[80:83], a[16:19], v[160:175]
    v_mfma_f32_32x32x16_bf16 v[176:191], v[84:87], a[16:19], v[176:191]
    s_waitcnt vmcnt(13)
    v_mfma_f32_32x32x16_bf16 v[160:175], v[88:91], a[20:23], v[160:175]
    v_mfma_f32_32x32x16_bf16 v[176:191], v[92:95], a[20:23], v[176:191]
    s_waitcnt vmcnt(12)
    v_mfma_f32_32x32x16_bf16 v[160:175], v[96:99], a[24:27], v[160:175]
    v_mfma_f32_32x32x16_bf16 v[176:191], v[100:103], a[24:27], v[176:191]
    s_waitcnt vmcnt(11)
    v_mfma_f32_32x32x16_bf16 v[160:175], v[104:107], a[28:31], v[160:175]
    v_mfma_f32_32x32x16_bf16 v[176:191], v[108:111], a[28:31], v[176:191]
    s_waitcnt vmcnt(10)
    v_mfma_f32_32x32x16_bf16 v[160:175], v[112:115], a[32:35], v[160:175]
    v_mfma_f32_32x32x16_bf16 v[176:191], v[116:119], a[32:35], v[176:191]
    s_waitcnt vmcnt(9)
    v_mfma_f32_32x32x16_bf16 v[160:175], v[120:123], a[36:39], v[160:175]
    v_mfma_f32_32x32x16_bf16 v[176:191], v[124:127], a[36:39], v[176:191]
    s_waitcnt vmcnt(8)
    v_mfma_f32_32x32x16_bf16 v[160:175], v[128:131], a[40:43], v[160:175]
    v_mfma_f32_32x32x16_bf16 v[176:191], v[132:135], a[40:43], v[176:191]
    s_waitcnt vmcnt(7)
    v_mfma_f32_32x32x16_bf16 v[160:175], v[136:139], a[44:47], v[160:175]
    v_mfma_f32_32x32x16_bf16 v[176:191], v[140:143], a[44:47], v[176:191]
    s_waitcnt vmcnt(6)
    v_mfma_f32_32x32x16_bf16 v[160:175], v[144:147], a[48:51], v[160:175]
    s_add_u32 s7, s6, 16384
    buffer_load_dwordx4 a[64:67], v2, s[12:15], s7 offen offset:0 sc1
    buffer_load_dwordx4 a[68:71], v2, s[12:15], s7 offen offset:1024 sc1
    v_mfma_f32_32x32x16_bf16 v[176:191], v[148:151], a[48:51], v[176:191]
    buffer_load_dwordx4 a[72:75], v2, s[12:15], s7 offen offset:2048 sc1
    buffer_load_dwordx4 a[76:79], v2, s[12:15], s7 offen offset:3072 sc1
    s_add_u32 s7, s6, 20480
    s_waitcnt vmcnt(9)
    v_mfma_f32_32x32x16_bf16 v[160:175], v[152:155], a[52:55], v[160:175]
    buffer_load_dwordx4 a[80:83], v2, s[12:15], s7 offen offset:0 sc1
    buffer_load_dwordx4 a[84:87], v2, s[12:15], s7 offen offset:1024 sc1
    v_mfma_f32_32x32x16_bf16 v[176:191], v[156:159], a[52:55], v[176:191]
    s_waitcnt vmcnt(10)
    v_mfma_f32_32x32x16_bf16 v[160:175], a[192:195], a[56:59], v[160:175]
    v_mfma_f32_32x32x16_bf16 v[176:191], a[196:199], a[56:59], v[176:191]
    s_waitcnt vmcnt(6)
    s_barrier
    s_cmp_lg_u32 s47, 3
    s_cbranch_scc1 L_nf7
    s_cmp_eq_u32 s72, 0
    s_cbranch_scc1 L_ff7
    buffer_store_dword v22, v23, s[12:15], s80 offen offset:3072
    s_branch L_nf7
L_ff7:
    buffer_store_dword v22, v23, s[12:15], s80 offen offset:3072 sc1
L_nf7:
    v_mfma_f32_32x32x16_bf16 v[160:175], a[200:203], a[60:63], v[160:175]
    v_mfma_f32_32x32x16_bf16 v[176:191], a[204:207], a[60:63], v[176:191]
    buffer_load_dword v4, v10, s[12:15], s66 offen offset:3072 sc1
L_hop5:
    s_cbranch_execz L_back1
    s_waitcnt vmcnt(0)
    v_cmp_ne_u32 vcc, 0, v4
    s_nop 1
    s_cmp_eq_u32 vcc_lo, 255
    s_cbranch_scc1 L_ok8
    s_mov_b32 s45, 0
L_spin8:
    buffer_load_dword v4, v10, s[12:15], s66 offen offset:3072 sc1
    s_add_u32 s45, s45, 1
    s_waitcnt vmcnt(0)
    v_cmp_ne_u32 vcc, 0, v4
    s_cmp_ge_u32 s45, 262144
    s_cbranch_scc1 L_ok8
    s_nop 1
    s_nop 1
    s_cmp_eq_u32 vcc_lo, 255
    s_cbranch_scc0 L_spin8
L_ok8:
    v_mfma_f32_32x32x16_bf16 v[160:175], a[208:211], a[64:67], v[160:175]
    s_add_u32 s7, s6, 90112
    buffer_load_dwordx4 a[88:91], v2, s[12:15], s7 offen offset:0 sc1
    v_mfma_f32_32x32x16_bf16 v[176:191], a[212:215], a[64:67], v[176:191]
    v_mfma_f32_32x32x16_bf16 v[160:175], a[216:219], a[68:71], v[160:175]
    buffer_load_dwordx4 a[92:95], v2, s[12:15], s7 offen offset:1024 sc1
    v_mfma_f32_32x32x16_bf16 v[176:191], a[220:223], a[68:71], v[176:191]
    v_mfma_f32_32x32x16_bf16 v[160:175], a[224:227], a[72:75], v[160:175]
    buffer_load_dwordx4 a[96:99], v2, s[12:15], s7 offen offset:2048 sc1
    v_mfma_f32_32x32x16_bf16 v[176:191], a[228:231], a[72:75], v[176:191]
    v_mfma_f32_32x32x16_bf16 v[160:175], a[232:235], a[76:79], v[160:175]
    buffer_load_dwordx4 a[100:103], v2, s[12:15], s7 offen offset:3072 sc1
    s_add_u32 s7, s6, 94208
    v_mfma_f32_32x32x16_bf16 v[176:191], a[236:239], a[76:79], v[176:191]
    v_mfma_f32_32x32x16_bf16 v[160:175], a[240:243], a[80:83], v[160:175]
    buffer_load_dwordx4 a[104:107], v2, s[12:15], s7 offen offset:0 sc1
    v_mfma_f32_32x32x16_bf16 v[176:191], a[244:247], a[80:83], v[176:191]
    v_mfma_f32_32x32x16_bf16 v[160:175], a[248:251], a[84:87], v[160:175]
    buffer_load_dwordx4 a[108:111], v2, s[12:15], s7 offen offset:1024 sc1
    v_mfma_f32_32x32x16_bf16 v[176:191], a[252:255], a[84:87], v[176:191]
    s_nop 9
    ds_write_b128 v16, v[168:171] offset:0
    buffer_load_dwordx4 a[112:115], v2, s[12:15], s7 offen offset:2048 sc1
    ds_write_b128 v16, v[172:175] offset:1024
    buffer_load_dwordx4 a[116:119], v2, s[12:15], s7 offen offset:3072 sc1
    ds_write_b128 v17, v[176:179] offset:0
    s_add_u32 s7, s6, 98304
    buffer_load_dwordx4 a[120:123], v2, s[12:15], s7 offen offset:0 sc1
    ds_write_b128 v17, v[180:183] offset:1024
    buffer_load_dwordx4 a[124:127], v2, s[12:15], s7 offen offset:1024 sc1
    ds_write_b128 v18, v[184:187] offset:0
    buffer_load_dwordx4 a[128:131], v2, s[12:15], s7 offen offset:2048 sc1
    ds_write_b128 v18, v[188:191] offset:1024
    buffer_load_dwordx4 a[132:135], v2, s[12:15], s7 offen offset:3072 sc1
    s_waitcnt lgkmcnt(0)
    s_barrier
    s_waitcnt vmcnt(11)
    v_mfma_f32_32x32x16_bf16 v[192:207], v[48:51], a[88:91], 0
    s_add_u32 s7, s6, 102400
    buffer_load_dwordx4 a[136:139], v2, s[12:15], s7 offen offset:0 sc1
    ds_read_b128 v[224:227], v19 offset:2048
    ds_read_b128 v[228:231], v19 offset:3072
    v_mfma_f32_32x32x16_bf16 v[208:223], v[52:55], a[88:91], 0
    ds_read_b128 v[232:235], v19 offset:4096
    ds_read_b128 v[236:239], v19 offset:5120
    s_waitcnt vmcnt(11)
    v_mfma_f32_32x32x16_bf16 v[192:207], v[56:59], a[92:95], v[192:207]
    buffer_load_dwordx4 a[140:143], v2, s[12:15], s7 offen offset:1024 sc1
    ds_read_b128 v[240:243], v19 offset:6144
    ds_read_b128 v[244:247], v19 offset:7168
    v_mfma_f32_32x32x16_bf16 v[208:223], v[60:63], a[92:95], v[208:223]
    s_waitcnt vmcnt(11)
    v_mfma_f32_32x32x16_bf16 v[192:207], v[64:67], a[96:99], v[192:207]
    buffer_load_dwordx4 a[144:147], v2, s[12:15], s7 offen offset:2048 sc1
    v_mfma_f32_32x32x16_bf16 v[208:223], v[68:71], a[96:99], v[208:223]
    s_waitcnt vmcnt(11)
    v_mfma_f32_32x32x16_bf16 v[192:207], v[72:75], a[100:103], v[192:207]
    buffer_load_dwordx4 a[148:151], v2, s[12:15], s7 offen offset:3072 sc1
    s_add_u32 s7, s6, 106496
    v_mfma_f32_32x32x16_bf16 v[208:223], v[76:79], a[100:103], v[208:223]
    s_waitcnt vmcnt(11)
    v_mfma_f32_32x32x16_bf16 v[192:207], v[80:83], a[104:107], v[192:207]
    buffer_load_dwordx4 a[152:155], v2, s[12:15], s7 offen offset:0 sc1
    v_add_f32 v160, v160, v32
    v_add_f32 v161, v161, v33
    v_add_f32_e64 v162, v162, v34
    v_mfma_f32_32x32x16_bf16 v[208:223], v[84:87], a[104:107], v[208:223]
    v_add_f32 v163, v163, v35
    v_add_f32 v164, v164, v36
    v_add_f32 v165, v165, v37
    v_add_f32 v166, v166, v38
    v_add_f32 v167, v167, v39
    s_waitcnt lgkmcnt(5)
    v_add_f32 v160, v160, v224
    s_waitcnt vmcnt(11)
    v_mfma_f32_32x32x16_bf16 v[192:207], v[88:91], a[108:111], v[192:207]
    buffer_load_dwordx4 a[156:159], v2, s[12:15], s7 offen offset:1024 sc1
    v_add_f32 v161, v161, v225
    v_add_f32 v162, v162, v226
    v_add_f32 v163, v163, v227
    v_mfma_f32_32x32x16_bf16 v[208:223], v[92:95], a[108:111], v[208:223]
    s_waitcnt lgkmcnt(4)
    v_add_f32 v164, v164, v228
    v_add_f32 v165, v165, v229
    v_add_f32 v166, v166, v230
    v_add_f32 v167, v167, v231
    s_waitcnt lgkmcnt(3)
    v_add_f32 v160, v160, v232
    v_add_f32 v161, v161, v233
    s_waitcnt vmcnt(11)
    v_mfma_f32_32x32x16_bf16 v[192:207], v[96:99], a[112:115], v[192:207]
    buffer_load_dwordx4 a[160:163], v2, s[12:15], s7 offen offset:2048 sc1
    v_add_f32 v162, v162, v234
    v_add_f32 v163, v163, v235
    s_waitcnt lgkmcnt(2)
    v_add_f32 v164, v164, v236
    v_mfma_f32_32x32x16_bf16 v[208:223], v[100:103], a[112:115], v[208:223]
    v_add_f32 v165, v165, v237
    v_add_f32 v166, v166, v238
    v_add_f32 v167, v167, v239
    s_waitcnt lgkmcnt(1)
    v_add_f32 v160, v160, v240
    v_add_f32 v161, v161, v241
    v_add_f32 v162, v162, v242
    s_waitcnt vmcnt(11)
    v_mfma_f32_32x32x16_bf16 v[192:207], v[104:107], a[116:119], v[192:207]
    buffer_load_dwordx4 a[164:167], v2, s[12:15], s7 offen offset:3072 sc1
    s_add_u32 s7, s6, 110592
    v_add_f32_e64 v163, v163, v243
    s_waitcnt lgkmcnt(0)
    v_add_f32 v164, v164, v244
    v_mfma_f32_32x32x16_bf16 v[208:223], v[108:111], a[116:119], v[208:223]
    v_add_f32 v165, v165, v245
    v_add_f32 v166, v166, v246
    v_add_f32 v167, v167, v247
    v_cvt_pk_bf16_f32 v248, v160, v161
    v_cvt_pk_bf16_f32 v249, v162, v163
    v_cvt_pk_bf16_f32 v250, v164, v165
    s_waitcnt vmcnt(11)
    v_mfma_f32_32x32x16_bf16 v[192:207], v[112:115], a[120:123], v[192:207]
    buffer_load_dwordx4 a[168:171], v2, s[12:15], s7 offen offset:0 sc1
    v_cvt_pk_bf16_f32 v251, v166, v167
    v_permlane32_swap_b32 v248, v250
    s_nop 0
    v_permlane32_swap_b32 v249, v251
    v_mfma_f32_32x32x16_bf16 v[208:223], v[116:119], a[120:123], v[208:223]
    s_waitcnt vmcnt(11)
    v_mfma_f32_32x32x16_bf16 v[192:207], v[120:123], a[124:127], v[192:207]
    buffer_load_dwordx4 a[172:175], v2, s[12:15], s7 offen offset:1024 sc1
    v_mfma_f32_32x32x16_bf16 v[208:223], v[124:127], a[124:127], v[208:223]
    s_waitcnt vmcnt(11)
    v_mfma_f32_32x32x16_bf16 v[192:207], v[128:131], a[128:131], v[192:207]
    buffer_store_dwordx4 v[248:251], v12, s[40:43], s4 offen
    v_mfma_f32_32x32x16_bf16 v[208:223], v[132:135], a[128:131], v[208:223]
    s_waitcnt vmcnt(11)
    v_mfma_f32_32x32x16_bf16 v[192:207], v[136:139], a[132:135], v[192:207]
    v_mfma_f32_32x32x16_bf16 v[208:223], v[140:143], a[132:135], v[208:223]
    s_waitcnt vmcnt(10)
    v_mfma_f32_32x32x16_bf16 v[192:207], v[144:147], a[136:139], v[192:207]
    v_mfma_f32_32x32x16_bf16 v[208:223], v[148:151], a[136:139], v[208:223]
    s_waitcnt vmcnt(9)
    v_mfma_f32_32x32x16_bf16 v[192:207], v[152:155], a[140:143], v[192:207]
    v_mfma_f32_32x32x16_bf16 v[208:223], v[156:159], a[140:143], v[208:223]
    s_waitcnt vmcnt(8)
    v_mfma_f32_32x32x16_bf16 v[192:207], a[192:195], a[144:147], v[192:207]
    v_mfma_f32_32x32x16_bf16 v[208:223], a[196:199], a[144:147], v[208:223]
    s_waitcnt vmcnt(7)
    v_mfma_f32_32x32x16_bf16 v[192:207], a[200:203], a[148:151], v[192:207]
    v_mfma_f32_32x32x16_bf16 v[208:223], a[204:207], a[148:151], v[208:223]
    s_waitcnt vmcnt(6)
    v_mfma_f32_32x32x16_bf16 v[192:207], a[208:211], a[152:155], v[192:207]
    v_mfma_f32_32x32x16_bf16 v[208:223], a[212:215], a[152:155], v[208:223]
    s_waitcnt vmcnt(5)
    v_mfma_f32_32x32x16_bf16 v[208:223], a[220:223], a[156:159], v[208:223]
    s_waitcnt vmcnt(4)
    v_mfma_f32_32x32x16_bf16 v[208:223], a[228:231], a[160:163], v[208:223]
    s_waitcnt vmcnt(3)
    v_mfma_f32_32x32x16_bf16 v[208:223], a[236:239], a[164:167], v[208:223]
    s_waitcnt vmcnt(2)
    v_mfma_f32_32x32x16_bf16 v[208:223], a[244:247], a[168:171], v[208:223]
    s_waitcnt vmcnt(1)
    v_mfma_f32_32x32x16_bf16 v[208:223], a[252:255], a[172:175], v[208:223]
    v_mfma_f32_32x32x16_bf16 v[192:207], a[216:219], a[156:159], v[192:207]
    v_mfma_f32_32x32x16_bf16 v[192:207], a[224:227], a[160:163], v[192:207]
    v_mfma_f32_32x32x16_bf16 v[192:207], a[232:235], a[164:167], v[192:207]
    s_nop 8
    ds_write_b128 v17, v[208:211] offset:32768
    v_mfma_f32_32x32x16_bf16 v[192:207], a[240:243], a[168:171], v[192:207]
    ds_write_b128 v17, v[212:215] offset:33792
    v_mfma_f32_32x32x16_bf16 v[192:207], a[248:251], a[172:175], v[192:207]
    ds_write_b128 v18, v[216:219] offset:32768
    ds_write_b128 v18, v[220:223] offset:33792
    s_nop 9
    ds_write_b128 v16, v[200:203] offset:32768
    ds_write_b128 v16, v[204:207] offset:33792
    s_waitcnt lgkmcnt(0)
    s_barrier
    ds_read_b128 v[224:227], v19 offset:34816
    ds_read_b128 v[228:231], v19 offset:35840
    ds_read_b128 v[232:235], v19 offset:36864
    ds_read_b128 v[236:239], v19 offset:37888
    ds_read_b128 v[240:243], v19 offset:38912
    ds_read_b128 v[244:247], v19 offset:39936
    v_pk_add_f32 v[192:193], v[192:193], v[24:25]
    v_pk_add_f32 v[194:195], v[194:195], v[26:27]
    v_pk_add_f32 v[196:197], v[196:197], v[28:29]
    v_pk_add_f32 v[198:199], v[198:199], v[30:31]
    s_waitcnt lgkmcnt(5)
    v_pk_add_f32 v[192:193], v[192:193], v[224:225]
    v_pk_add_f32 v[194:195], v[194:195], v[226:227]
    s_waitcnt lgkmcnt(4)
    v_pk_add_f32 v[196:197], v[196:197], v[228:229]
    v_pk_add_f32 v[198:199], v[198:199], v[230:231]
    s_waitcnt lgkmcnt(3)
    v_pk_add_f32 v[192:193], v[192:193], v[232:233]
    v_pk_add_f32 v[194:195], v[194:195], v[234:235]
    s_waitcnt lgkmcnt(2)
    v_pk_add_f32 v[196:197], v[196:197], v[236:237]
    v_pk_add_f32 v[198:199], v[198:199], v[238:239]
    s_waitcnt lgkmcnt(1)
    v_pk_add_f32 v[192:193], v[192:193], v[240:241]
    v_pk_add_f32 v[194:195], v[194:195], v[242:243]
    s_waitcnt lgkmcnt(0)
    v_pk_add_f32 v[196:197], v[196:197], v[244:245]
    v_pk_add_f32 v[198:199], v[198:199], v[246:247]
    v_cvt_pk_bf16_f32 v248, v192, v193
    v_cvt_pk_bf16_f32 v249, v194, v195
    v_cvt_pk_bf16_f32 v250, v196, v197
    v_cvt_pk_bf16_f32 v251, v198, v199
    s_nop 0
    v_permlane32_swap_b32 v248, v250
    v_permlane32_swap_b32 v249, v251
    s_add_u32 s4, s4, 32768
    buffer_store_dwordx4 v[248:251], v12, s[40:43], s4 offen
L_end:
    s_endpgm
.section .rodata,"a"
.p2align 6
.amdhsa_kernel sequential_preLN__linear_attn_block__mixer_channel_mlp__prompt_kernel
  .amdhsa_next_free_vgpr 512
  .amdhsa_next_free_sgpr 102
  .amdhsa_accum_offset 256
  .amdhsa_group_segment_fixed_size 0
  .amdhsa_kernarg_size 88
  .amdhsa_user_sgpr_count 2
  .amdhsa_user_sgpr_kernarg_segment_ptr 1
  .amdhsa_system_sgpr_workgroup_id_x 1
.end_amdhsa_kernel
```
